```python
import torch

def _softmax(x, axis=-1):
    return torch.softmax(x, dim=axis)
def _gelu(x):
    return torch.nn.functional.gelu(x, approximate="tanh")
def _silu(x):
    return torch.nn.functional.silu(x)
def _sigmoid(x):
    return torch.sigmoid(x)
def _layernorm(x, axis=-1, eps=1e-5):
    m = x.mean(dim=axis, keepdim=True)
    v = x.var(dim=axis, keepdim=True, unbiased=False)
    return (x - m) / torch.sqrt(v + eps)
def _scatter_add(tgt, idx, src, axis=0):
    return tgt.clone().index_add_(axis, idx, src)
def _segment_sum(src, seg, n):
    out = torch.zeros((n,) + src.shape[1:], dtype=src.dtype)
    return out.index_add_(0, seg, src)
def _pad(x, pw):
    flat = tuple(v for pair in reversed(pw) for v in pair)
    return torch.nn.functional.pad(x, flat)

kernel_name = 'sequential_preLN__mha_block_cached__swiglu_ffn__decode'

def setup_inputs():

    _w = (lambda a: (lambda t: t.to(torch.bfloat16) if t.is_floating_point() else t)(torch.as_tensor(a)))
    def _A_setup():
        B, Sq, D = 2, 1, 512
        H, Sk, Dh = 32, 16384, 128
        return {
            "x": _w((lambda *s: torch.randn(*s, dtype=torch.bfloat16) * 0.05)(B, Sq, D)),
            "k_cache": _w((lambda *s: torch.randn(*s, dtype=torch.bfloat16) * 3.2)(B, H, Sk, Dh)),
            "v_cache": _w((lambda *s: torch.randn(*s, dtype=torch.bfloat16) * 0.4)(B, H, Sk, Dh)),
            "wq": _w((lambda *s: torch.randn(*s, dtype=torch.bfloat16) * 3.2)(D, H * Dh) * (D ** -0.5)),
            "wo": _w((lambda *s: torch.randn(*s, dtype=torch.bfloat16) * 0.4)(H * Dh, D) * ((H * Dh) ** -0.5)),
        }
    _A_in = _A_setup()

    def _B_setup():
        B, S, D, F = 2, 1, 512, 1792
        return {
            "x": _w((lambda *s: torch.randn(*s, dtype=torch.bfloat16) * 0.05)(B, S, D)),
            "w_gate": _w((lambda *s: torch.randn(*s, dtype=torch.bfloat16) * 0.05)(D, F)),
            "w_up": _w((lambda *s: torch.randn(*s, dtype=torch.bfloat16) * 0.05)(D, F)),
            "w_down": _w((lambda *s: torch.randn(*s, dtype=torch.bfloat16) * 0.05)(F, D)),
        }
    _B_in = _B_setup()

    return {
        "A_x": _A_in["x"],
        "A_k_cache": _A_in["k_cache"],
        "A_v_cache": _A_in["v_cache"],
        "A_wq": _A_in["wq"],
        "A_wo": _A_in["wo"],
        "B_x": _B_in["x"],
        "B_w_gate": _B_in["w_gate"],
        "B_w_up": _B_in["w_up"],
        "B_w_down": _B_in["w_down"],
    }

def reference(A_x, A_k_cache, A_v_cache, A_wq, A_wo, B_x, B_w_gate, B_w_up, B_w_down):
    def _A_ref(x, k_cache, v_cache, wq, wo):
        B, Sq, D = x.shape
        H, Dh = 32, 128
        q = (lambda x, *d: x.permute(*d))((x @ wq).reshape(B, Sq, H, Dh), 0, 2, 1, 3)
        scores = torch.einsum("bhqd,bhkd->bhqk", q, k_cache) * (Dh ** -0.5)
        p = _softmax(scores, axis=-1)
        o = torch.einsum("bhqk,bhkd->bhqd", p, v_cache)
        return (lambda x, *d: x.permute(*d))(o, 0, 2, 1, 3).reshape(B, Sq, H * Dh) @ wo

    def _B_ref(x, w_gate, w_up, w_down):
        g = _silu(x @ w_gate)
        u = x @ w_up
        return (g * u) @ w_down

    x = A_x
    h = x + _A_ref(_layernorm(x, axis=-1), A_k_cache, A_v_cache, A_wq, A_wo)
    h2 = h + _B_ref(_layernorm(h, axis=-1), B_w_gate, B_w_up, B_w_down)
    return h2
```

```asm
; @launch grid=(256,1,1) block=(512,1,1) lds=61952
.amdgcn_target "amdgcn-amd-amdhsa--gfx950"
.text
.globl sequential_preLN__mha_block_cached__swiglu_ffn__decode_kernel
.p2align 8
.type sequential_preLN__mha_block_cached__swiglu_ffn__decode_kernel,@function
sequential_preLN__mha_block_cached__swiglu_ffn__decode_kernel:
  s_cmp_ge_u32 s2, 256
  s_cbranch_scc1 L_end
  s_load_dwordx8 s[4:11], s[0:1], 0
  s_load_dwordx2 s[12:13], s[0:1], 32
  s_load_dwordx4 s[64:67], s[0:1], 48
  s_load_dwordx4 s[68:71], s[0:1], 64
  s_load_dwordx4 s[16:19], s[0:1], 80
  v_and_b32 v1, 63, v0
  v_lshrrev_b32 v8, 6, v0
  v_lshlrev_b32 v2, 4, v1
  v_readfirstlane_b32 s52, v8
  v_add_u32 v3, 0x1000, v2
  s_lshr_b32 s48, s2, 2
  s_lshr_b32 s50, s48, 5
  s_and_b32 s51, s48, 31
  s_mov_b32 s56, 0x3db504f3
  s_mov_b32 s57, 0x3fb8aa3b
  s_and_b32 s55, s2, 3
  s_lshl_b32 s55, s55, 20
  s_lshl_b32 s53, s52, 13
  s_add_u32 s53, s53, s55
  s_add_u32 s54, s53, 0x10000
  v_and_b32 v9, 3, v0
  v_lshrrev_b32 v10, 2, v0
  s_movk_i32 s55, 3584
  v_mul_lo_u32 v11, v10, s55
  v_lshl_add_u32 v11, v9, 4, v11
  v_lshrrev_b32 v12, 4, v0
  v_and_b32 v13, 15, v0
  v_lshlrev_b32 v14, 13, v12
  v_lshl_add_u32 v14, v13, 4, v14
  v_mov_b32 v15, 0
  s_cmp_lg_u32 s52, 0
  s_cbranch_scc1 L_nolz
  ds_write_b32 v15, v15 offset:0
L_nolz:
  s_and_b32 s55, s2, 3
  s_and_b32 s49, s48, 3
  s_cmp_eq_u32 s55, s49
  s_cselect_b32 s49, s48, 64
  s_waitcnt lgkmcnt(0)
  s_lshl_b32 s55, s48, 22
  s_add_u32 s20, s6, s55
  s_addc_u32 s21, s7, 0
  s_and_b32 s21, s21, 0xffff
  s_mov_b32 s22, 4194304
  s_mov_b32 s23, 0x00020000
  s_add_u32 s24, s8, s55
  s_addc_u32 s25, s9, 0
  s_and_b32 s25, s25, 0xffff
  s_mov_b32 s26, 4194304
  s_mov_b32 s27, 0x00020000
  s_lshl_b32 s55, s51, 8
  s_add_u32 s28, s10, s55
  s_addc_u32 s29, s11, 0
  s_and_b32 s29, s29, 0xffff
  s_mov_b32 s30, 0
  s_mov_b32 s31, 0x00020000
  s_sub_u32 s30, 4194304, s55
  s_lshl_b32 s55, s51, 17
  s_add_u32 s32, s12, s55
  s_addc_u32 s33, s13, 0
  s_and_b32 s33, s33, 0xffff
  s_mov_b32 s34, 131072
  s_mov_b32 s35, 0x00020000
  s_mov_b32 s40, s18
  s_and_b32 s41, s19, 0xffff
  s_mov_b32 s42, 1048576
  s_mov_b32 s43, 0x00020000
  s_mov_b32 s44, s16
  s_and_b32 s45, s17, 0xffff
  s_mov_b32 s46, 256
  s_mov_b32 s47, 0x00020000
  s_mov_b32 s88, s4
  s_and_b32 s89, s5, 0xffff
  s_mov_b32 s90, 2048
  s_mov_b32 s91, 0x00020000
  s_mov_b32 s84, s70
  s_and_b32 s85, s71, 0xffff
  s_mov_b32 s86, 2048
  s_mov_b32 s87, 0x00020000
  s_and_b32 s55, s2, 3
  s_or_b32 s55, s55, s52
  s_cmp_lg_u32 s55, 0
  s_cbranch_scc1 L_nozc
  v_mov_b32 v15, 0
  s_lshl_b32 s55, s48, 8
  s_add_u32 s55, s55, 540672
  s_mov_b64 exec, 1
  buffer_store_dword v15, v15, s[40:43], s55 offen sc1
  s_waitcnt vmcnt(0)
  s_and_b32 s55, s48, 3
  s_lshl_b32 s55, s55, 3
  s_lshl_b32 s55, 1, s55
  v_mov_b32 v8, s55
  s_and_b32 s55, s48, 0xfc
  buffer_atomic_add v8, v15, s[44:47], s55 offen offset:64 sc1
  s_mov_b64 exec, -1
L_nozc:
  buffer_load_dwordx4 v[240:243], v2, s[88:91], 0 offen
  buffer_load_dwordx4 v[244:247], v2, s[88:91], 0 offen offset:1024
  s_mov_b32 s55, 0
  buffer_load_dwordx4 v[48:51], v14, s[28:31], s55 offen
  s_mov_b32 s55, 262144
  buffer_load_dwordx4 v[52:55], v14, s[28:31], s55 offen
  s_mov_b32 s55, 524288
  buffer_load_dwordx4 v[56:59], v14, s[28:31], s55 offen
  s_mov_b32 s55, 786432
  buffer_load_dwordx4 v[60:63], v14, s[28:31], s55 offen
  s_mov_b32 s55, 1048576
  buffer_load_dwordx4 v[64:67], v14, s[28:31], s55 offen
  s_mov_b32 s55, 1310720
  buffer_load_dwordx4 v[68:71], v14, s[28:31], s55 offen
  s_mov_b32 s55, 1572864
  buffer_load_dwordx4 v[72:75], v14, s[28:31], s55 offen
  s_mov_b32 s55, 1835008
  buffer_load_dwordx4 v[76:79], v14, s[28:31], s55 offen
  s_mov_b32 s55, 2097152
  buffer_load_dwordx4 v[112:115], v14, s[28:31], s55 offen
  s_mov_b32 s55, 2359296
  buffer_load_dwordx4 v[116:119], v14, s[28:31], s55 offen
  s_mov_b32 s55, 2621440
  buffer_load_dwordx4 v[120:123], v14, s[28:31], s55 offen
  s_mov_b32 s55, 2883584
  buffer_load_dwordx4 v[124:127], v14, s[28:31], s55 offen
  s_mov_b32 s55, 3145728
  buffer_load_dwordx4 v[128:131], v14, s[28:31], s55 offen
  s_mov_b32 s55, 3407872
  buffer_load_dwordx4 v[132:135], v14, s[28:31], s55 offen
  s_mov_b32 s55, 3670016
  buffer_load_dwordx4 v[136:139], v14, s[28:31], s55 offen
  s_mov_b32 s55, 3932160
  buffer_load_dwordx4 v[140:143], v14, s[28:31], s55 offen
  buffer_load_dwordx4 v[16:19], v2, s[20:23], s53 offen offset:0 sc1 nt
  buffer_load_dwordx4 v[20:23], v2, s[20:23], s53 offen offset:1024 sc1 nt
  buffer_load_dwordx4 v[24:27], v2, s[20:23], s53 offen offset:2048 sc1 nt
  buffer_load_dwordx4 v[28:31], v2, s[20:23], s53 offen offset:3072 sc1 nt
  buffer_load_dwordx4 v[32:35], v3, s[20:23], s53 offen offset:0 sc1 nt
  buffer_load_dwordx4 v[36:39], v3, s[20:23], s53 offen offset:1024 sc1 nt
  buffer_load_dwordx4 v[40:43], v3, s[20:23], s53 offen offset:2048 sc1 nt
  buffer_load_dwordx4 v[44:47], v3, s[20:23], s53 offen offset:3072 sc1 nt
  buffer_load_dwordx4 v[80:83], v2, s[24:27], s53 offen offset:0 sc1 nt
  buffer_load_dwordx4 v[84:87], v2, s[24:27], s53 offen offset:1024 sc1 nt
  buffer_load_dwordx4 v[88:91], v2, s[24:27], s53 offen offset:2048 sc1 nt
  buffer_load_dwordx4 v[92:95], v2, s[24:27], s53 offen offset:3072 sc1 nt
  buffer_load_dwordx4 v[96:99], v3, s[24:27], s53 offen offset:0 sc1 nt
  buffer_load_dwordx4 v[100:103], v3, s[24:27], s53 offen offset:1024 sc1 nt
  buffer_load_dwordx4 v[104:107], v3, s[24:27], s53 offen offset:2048 sc1 nt
  buffer_load_dwordx4 v[108:111], v3, s[24:27], s53 offen offset:3072 sc1 nt
  s_cmp_ge_u32 s49, 56
  s_cbranch_scc1 L_nopre
  s_lshl_b32 s55, s49, 6
  s_add_u32 s72, s64, s55
  s_addc_u32 s73, s65, 0
  s_and_b32 s73, s73, 0xffff
  s_mov_b32 s74, 0
  s_mov_b32 s75, 0x00020000
  s_sub_u32 s74, 1835008, s55
  s_add_u32 s76, s66, s55
  s_addc_u32 s77, s67, 0
  s_and_b32 s77, s77, 0xffff
  s_mov_b32 s78, 0
  s_mov_b32 s79, 0x00020000
  s_sub_u32 s78, 1835008, s55
  s_lshl_b32 s55, s49, 15
  s_add_u32 s80, s68, s55
  s_addc_u32 s81, s69, 0
  s_and_b32 s81, s81, 0xffff
  s_mov_b32 s82, 32768
  s_mov_b32 s83, 0x00020000
  s_mov_b32 s55, 0
  buffer_load_dwordx4 v[192:195], v11, s[72:75], s55 offen
  buffer_load_dwordx4 v[208:211], v11, s[76:79], s55 offen
  s_mov_b32 s55, 458752
  buffer_load_dwordx4 v[196:199], v11, s[72:75], s55 offen
  buffer_load_dwordx4 v[212:215], v11, s[76:79], s55 offen
  s_mov_b32 s55, 917504
  buffer_load_dwordx4 v[200:203], v11, s[72:75], s55 offen
  buffer_load_dwordx4 v[216:219], v11, s[76:79], s55 offen
  s_mov_b32 s55, 1376256
  buffer_load_dwordx4 v[204:207], v11, s[72:75], s55 offen
  buffer_load_dwordx4 v[220:223], v11, s[76:79], s55 offen
  s_lshl_b32 s55, s52, 10
  buffer_load_dwordx4 v[224:227], v2, s[80:83], s55 offen
  s_add_u32 s55, s55, 8192
  buffer_load_dwordx4 v[228:231], v2, s[80:83], s55 offen
  s_add_u32 s55, s55, 8192
  buffer_load_dwordx4 v[232:235], v2, s[80:83], s55 offen
  s_add_u32 s55, s55, 8192
  buffer_load_dwordx4 v[236:239], v2, s[80:83], s55 offen
  s_add_u32 s55, s55, 8192
  s_cmp_lg_u32 s2, 0
  s_cbranch_scc1 L_nopre
  v_mov_b32 v248, 0
  v_mov_b32 v249, 0
  v_mov_b32 v250, 0
  v_mov_b32 v251, 0
  v_lshlrev_b32 v15, 4, v0
  s_mov_b32 s55, 524288
  buffer_store_dwordx4 v[248:251], v15, s[40:43], s55 offen sc1
L_nopre:
  v_mov_b32 v8, 0
  s_and_b32 s62, s48, 0xfc
  buffer_load_dword v255, v8, s[44:47], s62 offen offset:64 sc1
  s_waitcnt vmcnt(33)
  s_cmp_eq_u32 s50, 0
  s_cbranch_scc1 L_xb0
  v_lshlrev_b32 v144, 16, v244
  v_and_b32 v145, 0xffff0000, v244
  v_lshlrev_b32 v146, 16, v245
  v_and_b32 v147, 0xffff0000, v245
  v_lshlrev_b32 v148, 16, v246
  v_and_b32 v149, 0xffff0000, v246
  v_lshlrev_b32 v150, 16, v247
  v_and_b32 v151, 0xffff0000, v247
  s_branch L_xbd
L_xb0:
  v_lshlrev_b32 v144, 16, v240
  v_and_b32 v145, 0xffff0000, v240
  v_lshlrev_b32 v146, 16, v241
  v_and_b32 v147, 0xffff0000, v241
  v_lshlrev_b32 v148, 16, v242
  v_and_b32 v149, 0xffff0000, v242
  v_lshlrev_b32 v150, 16, v243
  v_and_b32 v151, 0xffff0000, v243
L_xbd:
  v_add_f32 v178, v144, v145
  v_add_f32 v178, v178, v146
  v_add_f32 v178, v178, v147
  v_add_f32 v178, v178, v148
  v_add_f32 v178, v178, v149
  v_add_f32 v178, v178, v150
  v_add_f32 v178, v178, v151
  s_nop 1
  v_add_f32_dpp v178, v178, v178 quad_perm:[1,0,3,2] row_mask:0xf bank_mask:0xf
  s_nop 1
  v_add_f32_dpp v178, v178, v178 quad_perm:[2,3,0,1] row_mask:0xf bank_mask:0xf
  s_nop 1
  v_add_f32_dpp v178, v178, v178 row_half_mirror row_mask:0xf bank_mask:0xf
  s_nop 1
  v_add_f32_dpp v178, v178, v178 row_mirror row_mask:0xf bank_mask:0xf
  s_nop 1
  v_readlane_b32 s96, v178, 0
  v_readlane_b32 s97, v178, 16
  v_readlane_b32 s98, v178, 32
  v_readlane_b32 s99, v178, 48
  s_nop 2
  v_mov_b32 v178, s96
  v_add_f32 v178, s97, v178
  v_add_f32 v178, s98, v178
  v_add_f32 v178, s99, v178
  v_mul_f32 v178, 0x3b000000, v178
  v_sub_f32 v179, v144, v178
  v_mul_f32 v180, v179, v179
  v_sub_f32 v179, v145, v178
  v_fmac_f32 v180, v179, v179
  v_sub_f32 v179, v146, v178
  v_fmac_f32 v180, v179, v179
  v_sub_f32 v179, v147, v178
  v_fmac_f32 v180, v179, v179
  v_sub_f32 v179, v148, v178
  v_fmac_f32 v180, v179, v179
  v_sub_f32 v179, v149, v178
  v_fmac_f32 v180, v179, v179
  v_sub_f32 v179, v150, v178
  v_fmac_f32 v180, v179, v179
  v_sub_f32 v179, v151, v178
  v_fmac_f32 v180, v179, v179
  s_nop 1
  v_add_f32_dpp v180, v180, v180 quad_perm:[1,0,3,2] row_mask:0xf bank_mask:0xf
  s_nop 1
  v_add_f32_dpp v180, v180, v180 quad_perm:[2,3,0,1] row_mask:0xf bank_mask:0xf
  s_nop 1
  v_add_f32_dpp v180, v180, v180 row_half_mirror row_mask:0xf bank_mask:0xf
  s_nop 1
  v_add_f32_dpp v180, v180, v180 row_mirror row_mask:0xf bank_mask:0xf
  s_nop 1
  v_readlane_b32 s96, v180, 0
  v_readlane_b32 s97, v180, 16
  v_readlane_b32 s98, v180, 32
  v_readlane_b32 s99, v180, 48
  s_nop 2
  v_mov_b32 v180, s96
  v_add_f32 v180, s97, v180
  v_add_f32 v180, s98, v180
  v_add_f32 v180, s99, v180
  v_mul_f32 v180, 0x3b000000, v180
  v_cvt_pk_bf16_f32 v181, v178, v180
  v_lshlrev_b32 v178, 16, v181
  v_and_b32 v180, 0xffff0000, v181
  v_add_f32 v180, 0x3727c5ac, v180
  v_cvt_pk_bf16_f32 v181, v180, v180
  v_lshlrev_b32 v180, 16, v181
  v_and_b32 v179, 0xffff0000, v181
  v_sqrt_f32 v180, v180
  s_nop 0
  v_cvt_pk_bf16_f32 v181, v180, v180
  v_lshlrev_b32 v180, 16, v181
  v_and_b32 v179, 0xffff0000, v181
  v_rcp_f32 v179, v180
  s_nop 0
  v_fma_f32 v181, -v180, v179, 2.0
  v_mul_f32 v179, v179, v181
  v_sub_f32 v182, v144, v178
  v_sub_f32 v183, v145, v178
  v_sub_f32 v184, v146, v178
  v_sub_f32 v185, v147, v178
  v_sub_f32 v186, v148, v178
  v_sub_f32 v187, v149, v178
  v_sub_f32 v188, v150, v178
  v_sub_f32 v189, v151, v178
  v_cvt_pk_bf16_f32 v144, v182, v183
  v_cvt_pk_bf16_f32 v145, v184, v185
  v_cvt_pk_bf16_f32 v146, v186, v187
  v_cvt_pk_bf16_f32 v147, v188, v189
  v_lshlrev_b32 v182, 16, v144
  v_and_b32 v183, 0xffff0000, v144
  v_lshlrev_b32 v184, 16, v145
  v_and_b32 v185, 0xffff0000, v145
  v_lshlrev_b32 v186, 16, v146
  v_and_b32 v187, 0xffff0000, v146
  v_lshlrev_b32 v188, 16, v147
  v_and_b32 v189, 0xffff0000, v147
  v_mul_f32 v182, v182, v179
  v_mul_f32 v183, v183, v179
  v_mul_f32 v184, v184, v179
  v_mul_f32 v185, v185, v179
  v_mul_f32 v186, v186, v179
  v_mul_f32 v187, v187, v179
  v_mul_f32 v188, v188, v179
  v_mul_f32 v189, v189, v179
  v_cvt_pk_bf16_f32 v144, v182, v183
  v_cvt_pk_bf16_f32 v145, v184, v185
  v_cvt_pk_bf16_f32 v146, v186, v187
  v_cvt_pk_bf16_f32 v147, v188, v189
  v_and_b32 v152, 0xffff, v144
  v_lshrrev_b32 v153, 16, v144
  v_and_b32 v154, 0xffff, v145
  v_lshrrev_b32 v155, 16, v145
  v_and_b32 v156, 0xffff, v146
  v_lshrrev_b32 v157, 16, v146
  v_and_b32 v158, 0xffff, v147
  v_lshrrev_b32 v159, 16, v147
  s_cmp_lg_u32 s52, 0
  s_cbranch_scc1 L1_skipxn
  v_lshlrev_b32 v15, 5, v1
  ds_write_b128 v15, v[152:155] offset:51200
  ds_write_b128 v15, v[156:159] offset:51216
  s_waitcnt lgkmcnt(0)
L1_skipxn:
  s_barrier
  v_lshlrev_b32 v15, 2, v12
  ds_read_b32 v144, v15 offset:51200
  ds_read_b32 v145, v15 offset:51328
  ds_read_b32 v146, v15 offset:51456
  ds_read_b32 v147, v15 offset:51584
  ds_read_b32 v148, v15 offset:51712
  ds_read_b32 v149, v15 offset:51840
  ds_read_b32 v150, v15 offset:51968
  ds_read_b32 v151, v15 offset:52096
  ds_read_b32 v152, v15 offset:52224
  ds_read_b32 v153, v15 offset:52352
  ds_read_b32 v154, v15 offset:52480
  ds_read_b32 v155, v15 offset:52608
  ds_read_b32 v156, v15 offset:52736
  ds_read_b32 v157, v15 offset:52864
  ds_read_b32 v158, v15 offset:52992
  ds_read_b32 v159, v15 offset:53120
  v_mov_b32 v168, 0
  v_mov_b32 v169, 0
  v_mov_b32 v170, 0
  v_mov_b32 v171, 0
  v_mov_b32 v172, 0
  v_mov_b32 v173, 0
  v_mov_b32 v174, 0
  v_mov_b32 v175, 0
  s_waitcnt lgkmcnt(0)
  s_waitcnt vmcnt(17)
  v_lshlrev_b32 v178, 16, v144
  v_dot2_f32_bf16 v168, v48, v144, v168
  v_dot2_f32_bf16 v170, v49, v144, v170
  v_dot2_f32_bf16 v172, v50, v144, v172
  v_dot2_f32_bf16 v174, v51, v144, v174
  v_dot2_f32_bf16 v169, v48, v178, v169
  v_dot2_f32_bf16 v171, v49, v178, v171
  v_dot2_f32_bf16 v173, v50, v178, v173
  v_dot2_f32_bf16 v175, v51, v178, v175
  s_nop 2
  v_lshlrev_b32 v178, 16, v145
  v_dot2_f32_bf16 v168, v52, v145, v168
  v_dot2_f32_bf16 v170, v53, v145, v170
  v_dot2_f32_bf16 v172, v54, v145, v172
  v_dot2_f32_bf16 v174, v55, v145, v174
  v_dot2_f32_bf16 v169, v52, v178, v169
  v_dot2_f32_bf16 v171, v53, v178, v171
  v_dot2_f32_bf16 v173, v54, v178, v173
  v_dot2_f32_bf16 v175, v55, v178, v175
  s_nop 2
  v_lshlrev_b32 v178, 16, v146
  v_dot2_f32_bf16 v168, v56, v146, v168
  v_dot2_f32_bf16 v170, v57, v146, v170
  v_dot2_f32_bf16 v172, v58, v146, v172
  v_dot2_f32_bf16 v174, v59, v146, v174
  v_dot2_f32_bf16 v169, v56, v178, v169
  v_dot2_f32_bf16 v171, v57, v178, v171
  v_dot2_f32_bf16 v173, v58, v178, v173
  v_dot2_f32_bf16 v175, v59, v178, v175
  s_nop 2
  v_lshlrev_b32 v178, 16, v147
  v_dot2_f32_bf16 v168, v60, v147, v168
  v_dot2_f32_bf16 v170, v61, v147, v170
  v_dot2_f32_bf16 v172, v62, v147, v172
  v_dot2_f32_bf16 v174, v63, v147, v174
  v_dot2_f32_bf16 v169, v60, v178, v169
  v_dot2_f32_bf16 v171, v61, v178, v171
  v_dot2_f32_bf16 v173, v62, v178, v173
  v_dot2_f32_bf16 v175, v63, v178, v175
  s_nop 2
  v_lshlrev_b32 v178, 16, v148
  v_dot2_f32_bf16 v168, v64, v148, v168
  v_dot2_f32_bf16 v170, v65, v148, v170
  v_dot2_f32_bf16 v172, v66, v148, v172
  v_dot2_f32_bf16 v174, v67, v148, v174
  v_dot2_f32_bf16 v169, v64, v178, v169
  v_dot2_f32_bf16 v171, v65, v178, v171
  v_dot2_f32_bf16 v173, v66, v178, v173
  v_dot2_f32_bf16 v175, v67, v178, v175
  s_nop 2
  v_lshlrev_b32 v178, 16, v149
  v_dot2_f32_bf16 v168, v68, v149, v168
  v_dot2_f32_bf16 v170, v69, v149, v170
  v_dot2_f32_bf16 v172, v70, v149, v172
  v_dot2_f32_bf16 v174, v71, v149, v174
  v_dot2_f32_bf16 v169, v68, v178, v169
  v_dot2_f32_bf16 v171, v69, v178, v171
  v_dot2_f32_bf16 v173, v70, v178, v173
  v_dot2_f32_bf16 v175, v71, v178, v175
  s_nop 2
  v_lshlrev_b32 v178, 16, v150
  v_dot2_f32_bf16 v168, v72, v150, v168
  v_dot2_f32_bf16 v170, v73, v150, v170
  v_dot2_f32_bf16 v172, v74, v150, v172
  v_dot2_f32_bf16 v174, v75, v150, v174
  v_dot2_f32_bf16 v169, v72, v178, v169
  v_dot2_f32_bf16 v171, v73, v178, v171
  v_dot2_f32_bf16 v173, v74, v178, v173
  v_dot2_f32_bf16 v175, v75, v178, v175
  s_nop 2
  v_lshlrev_b32 v178, 16, v151
  v_dot2_f32_bf16 v168, v76, v151, v168
  v_dot2_f32_bf16 v170, v77, v151, v170
  v_dot2_f32_bf16 v172, v78, v151, v172
  v_dot2_f32_bf16 v174, v79, v151, v174
  v_dot2_f32_bf16 v169, v76, v178, v169
  v_dot2_f32_bf16 v171, v77, v178, v171
  v_dot2_f32_bf16 v173, v78, v178, v173
  v_dot2_f32_bf16 v175, v79, v178, v175
  s_nop 2
  v_lshlrev_b32 v178, 16, v152
  v_dot2_f32_bf16 v168, v112, v152, v168
  v_dot2_f32_bf16 v170, v113, v152, v170
  v_dot2_f32_bf16 v172, v114, v152, v172
  v_dot2_f32_bf16 v174, v115, v152, v174
  v_dot2_f32_bf16 v169, v112, v178, v169
  v_dot2_f32_bf16 v171, v113, v178, v171
  v_dot2_f32_bf16 v173, v114, v178, v173
  v_dot2_f32_bf16 v175, v115, v178, v175
  s_nop 2
  v_lshlrev_b32 v178, 16, v153
  v_dot2_f32_bf16 v168, v116, v153, v168
  v_dot2_f32_bf16 v170, v117, v153, v170
  v_dot2_f32_bf16 v172, v118, v153, v172
  v_dot2_f32_bf16 v174, v119, v153, v174
  v_dot2_f32_bf16 v169, v116, v178, v169
  v_dot2_f32_bf16 v171, v117, v178, v171
  v_dot2_f32_bf16 v173, v118, v178, v173
  v_dot2_f32_bf16 v175, v119, v178, v175
  s_nop 2
  v_lshlrev_b32 v178, 16, v154
  v_dot2_f32_bf16 v168, v120, v154, v168
  v_dot2_f32_bf16 v170, v121, v154, v170
  v_dot2_f32_bf16 v172, v122, v154, v172
  v_dot2_f32_bf16 v174, v123, v154, v174
  v_dot2_f32_bf16 v169, v120, v178, v169
  v_dot2_f32_bf16 v171, v121, v178, v171
  v_dot2_f32_bf16 v173, v122, v178, v173
  v_dot2_f32_bf16 v175, v123, v178, v175
  s_nop 2
  v_lshlrev_b32 v178, 16, v155
  v_dot2_f32_bf16 v168, v124, v155, v168
  v_dot2_f32_bf16 v170, v125, v155, v170
  v_dot2_f32_bf16 v172, v126, v155, v172
  v_dot2_f32_bf16 v174, v127, v155, v174
  v_dot2_f32_bf16 v169, v124, v178, v169
  v_dot2_f32_bf16 v171, v125, v178, v171
  v_dot2_f32_bf16 v173, v126, v178, v173
  v_dot2_f32_bf16 v175, v127, v178, v175
  s_nop 2
  v_lshlrev_b32 v178, 16, v156
  v_dot2_f32_bf16 v168, v128, v156, v168
  v_dot2_f32_bf16 v170, v129, v156, v170
  v_dot2_f32_bf16 v172, v130, v156, v172
  v_dot2_f32_bf16 v174, v131, v156, v174
  v_dot2_f32_bf16 v169, v128, v178, v169
  v_dot2_f32_bf16 v171, v129, v178, v171
  v_dot2_f32_bf16 v173, v130, v178, v173
  v_dot2_f32_bf16 v175, v131, v178, v175
  s_nop 2
  v_lshlrev_b32 v178, 16, v157
  v_dot2_f32_bf16 v168, v132, v157, v168
  v_dot2_f32_bf16 v170, v133, v157, v170
  v_dot2_f32_bf16 v172, v134, v157, v172
  v_dot2_f32_bf16 v174, v135, v157, v174
  v_dot2_f32_bf16 v169, v132, v178, v169
  v_dot2_f32_bf16 v171, v133, v178, v171
  v_dot2_f32_bf16 v173, v134, v178, v173
  v_dot2_f32_bf16 v175, v135, v178, v175
  s_nop 2
  v_lshlrev_b32 v178, 16, v158
  v_dot2_f32_bf16 v168, v136, v158, v168
  v_dot2_f32_bf16 v170, v137, v158, v170
  v_dot2_f32_bf16 v172, v138, v158, v172
  v_dot2_f32_bf16 v174, v139, v158, v174
  v_dot2_f32_bf16 v169, v136, v178, v169
  v_dot2_f32_bf16 v171, v137, v178, v171
  v_dot2_f32_bf16 v173, v138, v178, v173
  v_dot2_f32_bf16 v175, v139, v178, v175
  s_nop 2
  v_lshlrev_b32 v178, 16, v159
  v_dot2_f32_bf16 v168, v140, v159, v168
  v_dot2_f32_bf16 v170, v141, v159, v170
  v_dot2_f32_bf16 v172, v142, v159, v172
  v_dot2_f32_bf16 v174, v143, v159, v174
  v_dot2_f32_bf16 v169, v140, v178, v169
  v_dot2_f32_bf16 v171, v141, v178, v171
  v_dot2_f32_bf16 v173, v142, v178, v173
  v_dot2_f32_bf16 v175, v143, v178, v175
  s_nop 2
  buffer_load_dwordx4 v[48:51], v2, s[20:23], s54 offen offset:0 sc1 nt
  buffer_load_dwordx4 v[52:55], v2, s[20:23], s54 offen offset:1024 sc1 nt
  buffer_load_dwordx4 v[56:59], v2, s[20:23], s54 offen offset:2048 sc1 nt
  buffer_load_dwordx4 v[60:63], v2, s[20:23], s54 offen offset:3072 sc1 nt
  buffer_load_dwordx4 v[64:67], v3, s[20:23], s54 offen offset:0 sc1 nt
  buffer_load_dwordx4 v[68:71], v3, s[20:23], s54 offen offset:1024 sc1 nt
  buffer_load_dwordx4 v[72:75], v3, s[20:23], s54 offen offset:2048 sc1 nt
  buffer_load_dwordx4 v[76:79], v3, s[20:23], s54 offen offset:3072 sc1 nt
  v_lshlrev_b32 v15, 5, v0
  ds_write_b128 v15, v[168:171] offset:2048
  ds_write_b128 v15, v[172:175] offset:2064
  s_waitcnt lgkmcnt(0)
  s_barrier
  s_cmp_ge_u32 s52, 2
  s_cbranch_scc1 L1_skipq
  v_lshlrev_b32 v15, 2, v0
  ds_read_b32 v112, v15 offset:2048
  ds_read_b32 v113, v15 offset:2560
  ds_read_b32 v114, v15 offset:3072
  ds_read_b32 v115, v15 offset:3584
  ds_read_b32 v116, v15 offset:4096
  ds_read_b32 v117, v15 offset:4608
  ds_read_b32 v118, v15 offset:5120
  ds_read_b32 v119, v15 offset:5632
  ds_read_b32 v120, v15 offset:6144
  ds_read_b32 v121, v15 offset:6656
  ds_read_b32 v122, v15 offset:7168
  ds_read_b32 v123, v15 offset:7680
  ds_read_b32 v124, v15 offset:8192
  ds_read_b32 v125, v15 offset:8704
  ds_read_b32 v126, v15 offset:9216
  ds_read_b32 v127, v15 offset:9728
  ds_read_b32 v128, v15 offset:10240
  ds_read_b32 v129, v15 offset:10752
  ds_read_b32 v130, v15 offset:11264
  ds_read_b32 v131, v15 offset:11776
  ds_read_b32 v132, v15 offset:12288
  ds_read_b32 v133, v15 offset:12800
  ds_read_b32 v134, v15 offset:13312
  ds_read_b32 v135, v15 offset:13824
  ds_read_b32 v136, v15 offset:14336
  ds_read_b32 v137, v15 offset:14848
  ds_read_b32 v138, v15 offset:15360
  ds_read_b32 v139, v15 offset:15872
  ds_read_b32 v140, v15 offset:16384
  ds_read_b32 v141, v15 offset:16896
  ds_read_b32 v142, v15 offset:17408
  ds_read_b32 v143, v15 offset:17920
  s_waitcnt lgkmcnt(0)
  v_add_f32 v112, v112, v128
  v_add_f32 v113, v113, v129
  v_add_f32 v114, v114, v130
  v_add_f32 v115, v115, v131
  v_add_f32 v116, v116, v132
  v_add_f32 v117, v117, v133
  v_add_f32 v118, v118, v134
  v_add_f32 v119, v119, v135
  v_add_f32 v120, v120, v136
  v_add_f32 v121, v121, v137
  v_add_f32 v122, v122, v138
  v_add_f32 v123, v123, v139
  v_add_f32 v124, v124, v140
  v_add_f32 v125, v125, v141
  v_add_f32 v126, v126, v142
  v_add_f32 v127, v127, v143
  v_add_f32 v112, v112, v120
  v_add_f32 v113, v113, v121
  v_add_f32 v114, v114, v122
  v_add_f32 v115, v115, v123
  v_add_f32 v116, v116, v124
  v_add_f32 v117, v117, v125
  v_add_f32 v118, v118, v126
  v_add_f32 v119, v119, v127
  v_add_f32 v112, v112, v116
  v_add_f32 v113, v113, v117
  v_add_f32 v114, v114, v118
  v_add_f32 v115, v115, v119
  v_add_f32 v112, v112, v114
  v_add_f32 v113, v113, v115
  v_add_f32 v112, v112, v113
  v_cvt_pk_bf16_f32 v112, v112, v112
  v_lshlrev_b32 v15, 1, v0
  ds_write_b16 v15, v112 offset:55296
  s_waitcnt lgkmcnt(0)
L1_skipq:
  s_barrier
  v_and_b32 v15, 15, v1
  v_lshlrev_b32 v15, 4, v15
  ds_read_b128 v[4:7], v15 offset:55296
  v_mov_b32 v168, 0
  v_mov_b32 v169, 0
  v_mov_b32 v170, 0
  v_mov_b32 v171, 0
  v_mov_b32 v172, 0
  v_mov_b32 v173, 0
  v_mov_b32 v174, 0
  v_mov_b32 v175, 0
  v_mov_b32 v176, 0xff800000
  v_mov_b32 v177, 0
  v_mov_b32 v8, 0
  v_mov_b32 v9, 1
  s_lshl_b32 s63, s48, 8
  s_add_u32 s63, s63, 540672
  s_and_b32 s59, s48, 3
  s_lshl_b32 s59, s59, 3
  s_mov_b32 s58, 0
  s_waitcnt lgkmcnt(0) vmcnt(8)
L_zcpoll:
  v_readfirstlane_b32 s55, v255
  s_lshr_b32 s55, s55, s59
  s_and_b32 s55, s55, 0xff
  s_cmp_lg_u32 s55, 0
  s_cbranch_scc1 L_zcok
  s_sleep 1
  buffer_load_dword v255, v8, s[44:47], s62 offen offset:64 sc1
  s_waitcnt vmcnt(0)
  s_add_u32 s58, s58, 1
  s_cmp_lt_u32 s58, 400000
  s_cbranch_scc1 L_zcpoll
L_zcok:
  s_mov_b32 s58, 0
  s_and_b32 s53, s2, 3
  s_lshl_b32 s53, s53, 20
  s_cmp_lg_u32 s2, 0
  s_cbranch_scc1 L_nozf
  s_barrier
  s_cmp_lg_u32 s52, 0
  s_cbranch_scc1 L_nozf
  s_mov_b64 exec, 1
  buffer_atomic_add v9, v8, s[44:47], 0 offen offset:192 sc1
  s_mov_b64 exec, -1
  s_waitcnt vmcnt(0)
L_nozf:
  s_branch L_first
L1_loop:
  s_cmp_lg_u32 s58, 0
  s_cbranch_scc1 L_puba
  s_waitcnt lgkmcnt(0)
  v_readfirstlane_b32 s54, v190
  s_add_u32 s54, s54, 16
  s_cmp_ge_u32 s54, 112
  s_cbranch_scc1 L_transa
  s_lshl_b32 s54, s54, 13
  s_add_u32 s54, s54, s53
  buffer_load_dwordx4 v[48:51], v2, s[20:23], s54 offen offset:0 sc1 nt
  buffer_load_dwordx4 v[52:55], v2, s[20:23], s54 offen offset:1024 sc1 nt
  buffer_load_dwordx4 v[56:59], v2, s[20:23], s54 offen offset:2048 sc1 nt
  buffer_load_dwordx4 v[60:63], v2, s[20:23], s54 offen offset:3072 sc1 nt
  buffer_load_dwordx4 v[64:67], v3, s[20:23], s54 offen offset:0 sc1 nt
  buffer_load_dwordx4 v[68:71], v3, s[20:23], s54 offen offset:1024 sc1 nt
  buffer_load_dwordx4 v[72:75], v3, s[20:23], s54 offen offset:2048 sc1 nt
  buffer_load_dwordx4 v[76:79], v3, s[20:23], s54 offen offset:3072 sc1 nt
  s_waitcnt vmcnt(16)
L_first:
  s_mov_b64 exec, 1
  ds_add_rtn_u32 v190, v8, v9 offset:0
  s_mov_b64 exec, -1
  s_branch L_qka
L_transa:
  s_mov_b32 s58, 1
  s_mov_b64 exec, 1
  v_mov_b32 v190, v9
  buffer_atomic_add v190, v8, s[40:43], s63 offen sc0 sc1
  s_mov_b64 exec, -1
  s_waitcnt vmcnt(0)
L_puba:
  s_waitcnt vmcnt(8)
  v_readfirstlane_b32 s59, v190
  s_and_b32 s54, s59, 15
  s_add_u32 s54, s54, 112
  s_lshl_b32 s54, s54, 13
  s_lshr_b32 s55, s59, 4
  s_lshl_b32 s55, s55, 20
  s_add_u32 s54, s54, s55
  s_cmp_ge_u32 s59, 64
  s_cselect_b32 s54, 0x400000, s54
  buffer_load_dwordx4 v[48:51], v2, s[20:23], s54 offen offset:0 sc1 nt
  buffer_load_dwordx4 v[52:55], v2, s[20:23], s54 offen offset:1024 sc1 nt
  buffer_load_dwordx4 v[56:59], v2, s[20:23], s54 offen offset:2048 sc1 nt
  buffer_load_dwordx4 v[60:63], v2, s[20:23], s54 offen offset:3072 sc1 nt
  buffer_load_dwordx4 v[64:67], v3, s[20:23], s54 offen offset:0 sc1 nt
  buffer_load_dwordx4 v[68:71], v3, s[20:23], s54 offen offset:1024 sc1 nt
  buffer_load_dwordx4 v[72:75], v3, s[20:23], s54 offen offset:2048 sc1 nt
  buffer_load_dwordx4 v[76:79], v3, s[20:23], s54 offen offset:3072 sc1 nt
  s_mov_b64 exec, 1
  v_mov_b32 v190, v9
  buffer_atomic_add v190, v8, s[40:43], s63 offen sc0 sc1
  s_mov_b64 exec, -1
L_qka:
  v_dot2_f32_bf16 v144, v16, v4, 0
  v_dot2_f32_bf16 v145, v20, v4, 0
  v_dot2_f32_bf16 v146, v24, v4, 0
  v_dot2_f32_bf16 v147, v28, v4, 0
  v_dot2_f32_bf16 v148, v32, v4, 0
  v_dot2_f32_bf16 v149, v36, v4, 0
  v_dot2_f32_bf16 v150, v40, v4, 0
  v_dot2_f32_bf16 v151, v44, v4, 0
  v_dot2_f32_bf16 v144, v17, v5, v144
  v_dot2_f32_bf16 v145, v21, v5, v145
  v_dot2_f32_bf16 v146, v25, v5, v146
  v_dot2_f32_bf16 v147, v29, v5, v147
  v_dot2_f32_bf16 v148, v33, v5, v148
  v_dot2_f32_bf16 v149, v37, v5, v149
  v_dot2_f32_bf16 v150, v41, v5, v150
  v_dot2_f32_bf16 v151, v45, v5, v151
  v_dot2_f32_bf16 v144, v18, v6, v144
  v_dot2_f32_bf16 v145, v22, v6, v145
  v_dot2_f32_bf16 v146, v26, v6, v146
  v_dot2_f32_bf16 v147, v30, v6, v147
  v_dot2_f32_bf16 v148, v34, v6, v148
  v_dot2_f32_bf16 v149, v38, v6, v149
  v_dot2_f32_bf16 v150, v42, v6, v150
  v_dot2_f32_bf16 v151, v46, v6, v151
  v_dot2_f32_bf16 v144, v19, v7, v144
  v_dot2_f32_bf16 v145, v23, v7, v145
  v_dot2_f32_bf16 v146, v27, v7, v146
  v_dot2_f32_bf16 v147, v31, v7, v147
  v_dot2_f32_bf16 v148, v35, v7, v148
  v_dot2_f32_bf16 v149, v39, v7, v149
  v_dot2_f32_bf16 v150, v43, v7, v150
  v_dot2_f32_bf16 v151, v47, v7, v151
  v_add_f32_dpp v144, v144, v144 quad_perm:[1,0,3,2] row_mask:0xf bank_mask:0xf
  v_add_f32_dpp v145, v145, v145 quad_perm:[1,0,3,2] row_mask:0xf bank_mask:0xf
  v_add_f32_dpp v146, v146, v146 quad_perm:[1,0,3,2] row_mask:0xf bank_mask:0xf
  v_add_f32_dpp v147, v147, v147 quad_perm:[1,0,3,2] row_mask:0xf bank_mask:0xf
  v_add_f32_dpp v148, v148, v148 quad_perm:[1,0,3,2] row_mask:0xf bank_mask:0xf
  v_add_f32_dpp v149, v149, v149 quad_perm:[1,0,3,2] row_mask:0xf bank_mask:0xf
  v_add_f32_dpp v150, v150, v150 quad_perm:[1,0,3,2] row_mask:0xf bank_mask:0xf
  v_add_f32_dpp v151, v151, v151 quad_perm:[1,0,3,2] row_mask:0xf bank_mask:0xf
  v_add_f32_dpp v144, v144, v144 quad_perm:[2,3,0,1] row_mask:0xf bank_mask:0xf
  v_add_f32_dpp v145, v145, v145 quad_perm:[2,3,0,1] row_mask:0xf bank_mask:0xf
  v_add_f32_dpp v146, v146, v146 quad_perm:[2,3,0,1] row_mask:0xf bank_mask:0xf
  v_add_f32_dpp v147, v147, v147 quad_perm:[2,3,0,1] row_mask:0xf bank_mask:0xf
  v_add_f32_dpp v148, v148, v148 quad_perm:[2,3,0,1] row_mask:0xf bank_mask:0xf
  v_add_f32_dpp v149, v149, v149 quad_perm:[2,3,0,1] row_mask:0xf bank_mask:0xf
  v_add_f32_dpp v150, v150, v150 quad_perm:[2,3,0,1] row_mask:0xf bank_mask:0xf
  v_add_f32_dpp v151, v151, v151 quad_perm:[2,3,0,1] row_mask:0xf bank_mask:0xf
  v_add_f32_dpp v144, v144, v144 row_half_mirror row_mask:0xf bank_mask:0xf
  v_add_f32_dpp v145, v145, v145 row_half_mirror row_mask:0xf bank_mask:0xf
  v_add_f32_dpp v146, v146, v146 row_half_mirror row_mask:0xf bank_mask:0xf
  v_add_f32_dpp v147, v147, v147 row_half_mirror row_mask:0xf bank_mask:0xf
  v_add_f32_dpp v148, v148, v148 row_half_mirror row_mask:0xf bank_mask:0xf
  v_add_f32_dpp v149, v149, v149 row_half_mirror row_mask:0xf bank_mask:0xf
  v_add_f32_dpp v150, v150, v150 row_half_mirror row_mask:0xf bank_mask:0xf
  v_add_f32_dpp v151, v151, v151 row_half_mirror row_mask:0xf bank_mask:0xf
  v_add_f32_dpp v144, v144, v144 row_mirror row_mask:0xf bank_mask:0xf
  v_add_f32_dpp v145, v145, v145 row_mirror row_mask:0xf bank_mask:0xf
  v_add_f32_dpp v146, v146, v146 row_mirror row_mask:0xf bank_mask:0xf
  v_add_f32_dpp v147, v147, v147 row_mirror row_mask:0xf bank_mask:0xf
  v_add_f32_dpp v148, v148, v148 row_mirror row_mask:0xf bank_mask:0xf
  v_add_f32_dpp v149, v149, v149 row_mirror row_mask:0xf bank_mask:0xf
  v_add_f32_dpp v150, v150, v150 row_mirror row_mask:0xf bank_mask:0xf
  v_add_f32_dpp v151, v151, v151 row_mirror row_mask:0xf bank_mask:0xf
  v_cvt_pk_bf16_f32 v152, v144, v145
  v_cvt_pk_bf16_f32 v153, v146, v147
  v_cvt_pk_bf16_f32 v154, v148, v149
  v_cvt_pk_bf16_f32 v155, v150, v151
  v_lshlrev_b32 v144, 16, v152
  v_and_b32 v145, 0xffff0000, v152
  v_lshlrev_b32 v146, 16, v153
  v_and_b32 v147, 0xffff0000, v153
  v_lshlrev_b32 v148, 16, v154
  v_and_b32 v149, 0xffff0000, v154
  v_lshlrev_b32 v150, 16, v155
  v_and_b32 v151, 0xffff0000, v155
  v_mul_f32 v144, s56, v144
  v_mul_f32 v145, s56, v145
  v_mul_f32 v146, s56, v146
  v_mul_f32 v147, s56, v147
  v_mul_f32 v148, s56, v148
  v_mul_f32 v149, s56, v149
  v_mul_f32 v150, s56, v150
  v_mul_f32 v151, s56, v151
  v_cvt_pk_bf16_f32 v152, v144, v145
  v_cvt_pk_bf16_f32 v153, v146, v147
  v_cvt_pk_bf16_f32 v154, v148, v149
  v_cvt_pk_bf16_f32 v155, v150, v151
  v_lshlrev_b32 v144, 16, v152
  v_and_b32 v145, 0xffff0000, v152
  v_lshlrev_b32 v146, 16, v153
  v_and_b32 v147, 0xffff0000, v153
  v_lshlrev_b32 v148, 16, v154
  v_and_b32 v149, 0xffff0000, v154
  v_lshlrev_b32 v150, 16, v155
  v_and_b32 v151, 0xffff0000, v155
  buffer_load_dwordx4 v[112:115], v2, s[24:27], s54 offen offset:0 sc1 nt
  buffer_load_dwordx4 v[116:119], v2, s[24:27], s54 offen offset:1024 sc1 nt
  buffer_load_dwordx4 v[120:123], v2, s[24:27], s54 offen offset:2048 sc1 nt
  buffer_load_dwordx4 v[124:127], v2, s[24:27], s54 offen offset:3072 sc1 nt
  buffer_load_dwordx4 v[128:131], v3, s[24:27], s54 offen offset:0 sc1 nt
  buffer_load_dwordx4 v[132:135], v3, s[24:27], s54 offen offset:1024 sc1 nt
  buffer_load_dwordx4 v[136:139], v3, s[24:27], s54 offen offset:2048 sc1 nt
  buffer_load_dwordx4 v[140:143], v3, s[24:27], s54 offen offset:3072 sc1 nt
  v_max3_f32 v178, v144, v145, v146
  v_max3_f32 v179, v147, v148, v149
  v_max3_f32 v180, v150, v151, v176
  v_max3_f32 v178, v178, v179, v180
  v_mul_f32 v179, s57, v178
  v_fma_f32 v180, v176, s57, -v179
  v_mov_b32 v176, v178
  v_exp_f32 v180, v180
  v_fma_f32 v144, v144, s57, -v179
  v_fma_f32 v145, v145, s57, -v179
  v_fma_f32 v146, v146, s57, -v179
  v_fma_f32 v147, v147, s57, -v179
  v_fma_f32 v148, v148, s57, -v179
  v_fma_f32 v149, v149, s57, -v179
  v_fma_f32 v150, v150, s57, -v179
  v_fma_f32 v151, v151, s57, -v179
  v_exp_f32 v144, v144
  v_exp_f32 v145, v145
  v_exp_f32 v146, v146
  v_exp_f32 v147, v147
  v_exp_f32 v148, v148
  v_exp_f32 v149, v149
  v_exp_f32 v150, v150
  v_exp_f32 v151, v151
  v_mul_f32 v177, v177, v180
  v_mul_f32 v168, v168, v180
  v_mul_f32 v169, v169, v180
  v_mul_f32 v170, v170, v180
  v_mul_f32 v171, v171, v180
  v_mul_f32 v172, v172, v180
  v_mul_f32 v173, v173, v180
  v_mul_f32 v174, v174, v180
  v_mul_f32 v175, v175, v180
  v_cvt_pk_bf16_f32 v152, v144, 0
  v_cvt_pk_bf16_f32 v160, 0, v144
  v_cvt_pk_bf16_f32 v153, v145, 0
  v_cvt_pk_bf16_f32 v161, 0, v145
  v_cvt_pk_bf16_f32 v154, v146, 0
  v_cvt_pk_bf16_f32 v162, 0, v146
  v_cvt_pk_bf16_f32 v155, v147, 0
  v_cvt_pk_bf16_f32 v163, 0, v147
  v_cvt_pk_bf16_f32 v156, v148, 0
  v_cvt_pk_bf16_f32 v164, 0, v148
  v_cvt_pk_bf16_f32 v157, v149, 0
  v_cvt_pk_bf16_f32 v165, 0, v149
  v_cvt_pk_bf16_f32 v158, v150, 0
  v_cvt_pk_bf16_f32 v166, 0, v150
  v_cvt_pk_bf16_f32 v159, v151, 0
  v_cvt_pk_bf16_f32 v167, 0, v151
  v_add_f32 v178, v144, v145
  v_add_f32 v179, v146, v147
  v_add_f32 v181, v148, v149
  v_add_f32 v182, v150, v151
  v_add_f32 v178, v178, v179
  v_add_f32 v181, v181, v182
  v_add_f32 v178, v178, v181
  v_add_f32 v177, v177, v178
  s_waitcnt vmcnt(16)
  v_dot2_f32_bf16 v168, v80, v152, v168
  v_dot2_f32_bf16 v169, v80, v160, v169
  v_dot2_f32_bf16 v170, v81, v152, v170
  v_dot2_f32_bf16 v171, v81, v160, v171
  v_dot2_f32_bf16 v172, v82, v152, v172
  v_dot2_f32_bf16 v173, v82, v160, v173
  v_dot2_f32_bf16 v174, v83, v152, v174
  v_dot2_f32_bf16 v175, v83, v160, v175
  v_dot2_f32_bf16 v168, v84, v153, v168
  v_dot2_f32_bf16 v169, v84, v161, v169
  v_dot2_f32_bf16 v170, v85, v153, v170
  v_dot2_f32_bf16 v171, v85, v161, v171
  v_dot2_f32_bf16 v172, v86, v153, v172
  v_dot2_f32_bf16 v173, v86, v161, v173
  v_dot2_f32_bf16 v174, v87, v153, v174
  v_dot2_f32_bf16 v175, v87, v161, v175
  v_dot2_f32_bf16 v168, v88, v154, v168
  v_dot2_f32_bf16 v169, v88, v162, v169
  v_dot2_f32_bf16 v170, v89, v154, v170
  v_dot2_f32_bf16 v171, v89, v162, v171
  v_dot2_f32_bf16 v172, v90, v154, v172
  v_dot2_f32_bf16 v173, v90, v162, v173
  v_dot2_f32_bf16 v174, v91, v154, v174
  v_dot2_f32_bf16 v175, v91, v162, v175
  v_dot2_f32_bf16 v168, v92, v155, v168
  v_dot2_f32_bf16 v169, v92, v163, v169
  v_dot2_f32_bf16 v170, v93, v155, v170
  v_dot2_f32_bf16 v171, v93, v163, v171
  v_dot2_f32_bf16 v172, v94, v155, v172
  v_dot2_f32_bf16 v173, v94, v163, v173
  v_dot2_f32_bf16 v174, v95, v155, v174
  v_dot2_f32_bf16 v175, v95, v163, v175
  v_dot2_f32_bf16 v168, v96, v156, v168
  v_dot2_f32_bf16 v169, v96, v164, v169
  v_dot2_f32_bf16 v170, v97, v156, v170
  v_dot2_f32_bf16 v171, v97, v164, v171
  v_dot2_f32_bf16 v172, v98, v156, v172
  v_dot2_f32_bf16 v173, v98, v164, v173
  v_dot2_f32_bf16 v174, v99, v156, v174
  v_dot2_f32_bf16 v175, v99, v164, v175
  v_dot2_f32_bf16 v168, v100, v157, v168
  v_dot2_f32_bf16 v169, v100, v165, v169
  v_dot2_f32_bf16 v170, v101, v157, v170
  v_dot2_f32_bf16 v171, v101, v165, v171
  v_dot2_f32_bf16 v172, v102, v157, v172
  v_dot2_f32_bf16 v173, v102, v165, v173
  v_dot2_f32_bf16 v174, v103, v157, v174
  v_dot2_f32_bf16 v175, v103, v165, v175
  v_dot2_f32_bf16 v168, v104, v158, v168
  v_dot2_f32_bf16 v169, v104, v166, v169
  v_dot2_f32_bf16 v170, v105, v158, v170
  v_dot2_f32_bf16 v171, v105, v166, v171
  v_dot2_f32_bf16 v172, v106, v158, v172
  v_dot2_f32_bf16 v173, v106, v166, v173
  v_dot2_f32_bf16 v174, v107, v158, v174
  v_dot2_f32_bf16 v175, v107, v166, v175
  v_dot2_f32_bf16 v168, v108, v159, v168
  v_dot2_f32_bf16 v169, v108, v167, v169
  v_dot2_f32_bf16 v170, v109, v159, v170
  v_dot2_f32_bf16 v171, v109, v167, v171
  v_dot2_f32_bf16 v172, v110, v159, v172
  v_dot2_f32_bf16 v173, v110, v167, v173
  v_dot2_f32_bf16 v174, v111, v159, v174
  v_dot2_f32_bf16 v175, v111, v167, v175
  s_cmp_ge_u32 s54, 0x400000
  s_cbranch_scc1 L1_done
  s_cmp_lg_u32 s58, 0
  s_cbranch_scc1 L_pubb
  s_waitcnt lgkmcnt(0)
  v_readfirstlane_b32 s54, v190
  s_add_u32 s54, s54, 16
  s_cmp_ge_u32 s54, 112
  s_cbranch_scc1 L_transb
  s_lshl_b32 s54, s54, 13
  s_add_u32 s54, s54, s53
  buffer_load_dwordx4 v[16:19], v2, s[20:23], s54 offen offset:0 sc1 nt
  buffer_load_dwordx4 v[20:23], v2, s[20:23], s54 offen offset:1024 sc1 nt
  buffer_load_dwordx4 v[24:27], v2, s[20:23], s54 offen offset:2048 sc1 nt
  buffer_load_dwordx4 v[28:31], v2, s[20:23], s54 offen offset:3072 sc1 nt
  buffer_load_dwordx4 v[32:35], v3, s[20:23], s54 offen offset:0 sc1 nt
  buffer_load_dwordx4 v[36:39], v3, s[20:23], s54 offen offset:1024 sc1 nt
  buffer_load_dwordx4 v[40:43], v3, s[20:23], s54 offen offset:2048 sc1 nt
  buffer_load_dwordx4 v[44:47], v3, s[20:23], s54 offen offset:3072 sc1 nt
  s_waitcnt vmcnt(16)
  s_mov_b64 exec, 1
  ds_add_rtn_u32 v190, v8, v9 offset:0
  s_mov_b64 exec, -1
  s_branch L_qkb
L_transb:
  s_mov_b32 s58, 1
  s_mov_b64 exec, 1
  v_mov_b32 v190, v9
  buffer_atomic_add v190, v8, s[40:43], s63 offen sc0 sc1
  s_mov_b64 exec, -1
  s_waitcnt vmcnt(0)
L_pubb:
  s_waitcnt vmcnt(8)
  v_readfirstlane_b32 s59, v190
  s_and_b32 s54, s59, 15
  s_add_u32 s54, s54, 112
  s_lshl_b32 s54, s54, 13
  s_lshr_b32 s55, s59, 4
  s_lshl_b32 s55, s55, 20
  s_add_u32 s54, s54, s55
  s_cmp_ge_u32 s59, 64
  s_cselect_b32 s54, 0x400000, s54
  buffer_load_dwordx4 v[16:19], v2, s[20:23], s54 offen offset:0 sc1 nt
  buffer_load_dwordx4 v[20:23], v2, s[20:23], s54 offen offset:1024 sc1 nt
  buffer_load_dwordx4 v[24:27], v2, s[20:23], s54 offen offset:2048 sc1 nt
  buffer_load_dwordx4 v[28:31], v2, s[20:23], s54 offen offset:3072 sc1 nt
  buffer_load_dwordx4 v[32:35], v3, s[20:23], s54 offen offset:0 sc1 nt
  buffer_load_dwordx4 v[36:39], v3, s[20:23], s54 offen offset:1024 sc1 nt
  buffer_load_dwordx4 v[40:43], v3, s[20:23], s54 offen offset:2048 sc1 nt
  buffer_load_dwordx4 v[44:47], v3, s[20:23], s54 offen offset:3072 sc1 nt
  s_mov_b64 exec, 1
  v_mov_b32 v190, v9
  buffer_atomic_add v190, v8, s[40:43], s63 offen sc0 sc1
  s_mov_b64 exec, -1
L_qkb:
  v_dot2_f32_bf16 v144, v48, v4, 0
  v_dot2_f32_bf16 v145, v52, v4, 0
  v_dot2_f32_bf16 v146, v56, v4, 0
  v_dot2_f32_bf16 v147, v60, v4, 0
  v_dot2_f32_bf16 v148, v64, v4, 0
  v_dot2_f32_bf16 v149, v68, v4, 0
  v_dot2_f32_bf16 v150, v72, v4, 0
  v_dot2_f32_bf16 v151, v76, v4, 0
  v_dot2_f32_bf16 v144, v49, v5, v144
  v_dot2_f32_bf16 v145, v53, v5, v145
  v_dot2_f32_bf16 v146, v57, v5, v146
  v_dot2_f32_bf16 v147, v61, v5, v147
  v_dot2_f32_bf16 v148, v65, v5, v148
  v_dot2_f32_bf16 v149, v69, v5, v149
  v_dot2_f32_bf16 v150, v73, v5, v150
  v_dot2_f32_bf16 v151, v77, v5, v151
  v_dot2_f32_bf16 v144, v50, v6, v144
  v_dot2_f32_bf16 v145, v54, v6, v145
  v_dot2_f32_bf16 v146, v58, v6, v146
  v_dot2_f32_bf16 v147, v62, v6, v147
  v_dot2_f32_bf16 v148, v66, v6, v148
  v_dot2_f32_bf16 v149, v70, v6, v149
  v_dot2_f32_bf16 v150, v74, v6, v150
  v_dot2_f32_bf16 v151, v78, v6, v151
  v_dot2_f32_bf16 v144, v51, v7, v144
  v_dot2_f32_bf16 v145, v55, v7, v145
  v_dot2_f32_bf16 v146, v59, v7, v146
  v_dot2_f32_bf16 v147, v63, v7, v147
  v_dot2_f32_bf16 v148, v67, v7, v148
  v_dot2_f32_bf16 v149, v71, v7, v149
  v_dot2_f32_bf16 v150, v75, v7, v150
  v_dot2_f32_bf16 v151, v79, v7, v151
  v_add_f32_dpp v144, v144, v144 quad_perm:[1,0,3,2] row_mask:0xf bank_mask:0xf
  v_add_f32_dpp v145, v145, v145 quad_perm:[1,0,3,2] row_mask:0xf bank_mask:0xf
  v_add_f32_dpp v146, v146, v146 quad_perm:[1,0,3,2] row_mask:0xf bank_mask:0xf
  v_add_f32_dpp v147, v147, v147 quad_perm:[1,0,3,2] row_mask:0xf bank_mask:0xf
  v_add_f32_dpp v148, v148, v148 quad_perm:[1,0,3,2] row_mask:0xf bank_mask:0xf
  v_add_f32_dpp v149, v149, v149 quad_perm:[1,0,3,2] row_mask:0xf bank_mask:0xf
  v_add_f32_dpp v150, v150, v150 quad_perm:[1,0,3,2] row_mask:0xf bank_mask:0xf
  v_add_f32_dpp v151, v151, v151 quad_perm:[1,0,3,2] row_mask:0xf bank_mask:0xf
  v_add_f32_dpp v144, v144, v144 quad_perm:[2,3,0,1] row_mask:0xf bank_mask:0xf
  v_add_f32_dpp v145, v145, v145 quad_perm:[2,3,0,1] row_mask:0xf bank_mask:0xf
  v_add_f32_dpp v146, v146, v146 quad_perm:[2,3,0,1] row_mask:0xf bank_mask:0xf
  v_add_f32_dpp v147, v147, v147 quad_perm:[2,3,0,1] row_mask:0xf bank_mask:0xf
  v_add_f32_dpp v148, v148, v148 quad_perm:[2,3,0,1] row_mask:0xf bank_mask:0xf
  v_add_f32_dpp v149, v149, v149 quad_perm:[2,3,0,1] row_mask:0xf bank_mask:0xf
  v_add_f32_dpp v150, v150, v150 quad_perm:[2,3,0,1] row_mask:0xf bank_mask:0xf
  v_add_f32_dpp v151, v151, v151 quad_perm:[2,3,0,1] row_mask:0xf bank_mask:0xf
  v_add_f32_dpp v144, v144, v144 row_half_mirror row_mask:0xf bank_mask:0xf
  v_add_f32_dpp v145, v145, v145 row_half_mirror row_mask:0xf bank_mask:0xf
  v_add_f32_dpp v146, v146, v146 row_half_mirror row_mask:0xf bank_mask:0xf
  v_add_f32_dpp v147, v147, v147 row_half_mirror row_mask:0xf bank_mask:0xf
  v_add_f32_dpp v148, v148, v148 row_half_mirror row_mask:0xf bank_mask:0xf
  v_add_f32_dpp v149, v149, v149 row_half_mirror row_mask:0xf bank_mask:0xf
  v_add_f32_dpp v150, v150, v150 row_half_mirror row_mask:0xf bank_mask:0xf
  v_add_f32_dpp v151, v151, v151 row_half_mirror row_mask:0xf bank_mask:0xf
  v_add_f32_dpp v144, v144, v144 row_mirror row_mask:0xf bank_mask:0xf
  v_add_f32_dpp v145, v145, v145 row_mirror row_mask:0xf bank_mask:0xf
  v_add_f32_dpp v146, v146, v146 row_mirror row_mask:0xf bank_mask:0xf
  v_add_f32_dpp v147, v147, v147 row_mirror row_mask:0xf bank_mask:0xf
  v_add_f32_dpp v148, v148, v148 row_mirror row_mask:0xf bank_mask:0xf
  v_add_f32_dpp v149, v149, v149 row_mirror row_mask:0xf bank_mask:0xf
  v_add_f32_dpp v150, v150, v150 row_mirror row_mask:0xf bank_mask:0xf
  v_add_f32_dpp v151, v151, v151 row_mirror row_mask:0xf bank_mask:0xf
  v_cvt_pk_bf16_f32 v152, v144, v145
  v_cvt_pk_bf16_f32 v153, v146, v147
  v_cvt_pk_bf16_f32 v154, v148, v149
  v_cvt_pk_bf16_f32 v155, v150, v151
  v_lshlrev_b32 v144, 16, v152
  v_and_b32 v145, 0xffff0000, v152
  v_lshlrev_b32 v146, 16, v153
  v_and_b32 v147, 0xffff0000, v153
  v_lshlrev_b32 v148, 16, v154
  v_and_b32 v149, 0xffff0000, v154
  v_lshlrev_b32 v150, 16, v155
  v_and_b32 v151, 0xffff0000, v155
  v_mul_f32 v144, s56, v144
  v_mul_f32 v145, s56, v145
  v_mul_f32 v146, s56, v146
  v_mul_f32 v147, s56, v147
  v_mul_f32 v148, s56, v148
  v_mul_f32 v149, s56, v149
  v_mul_f32 v150, s56, v150
  v_mul_f32 v151, s56, v151
  v_cvt_pk_bf16_f32 v152, v144, v145
  v_cvt_pk_bf16_f32 v153, v146, v147
  v_cvt_pk_bf16_f32 v154, v148, v149
  v_cvt_pk_bf16_f32 v155, v150, v151
  v_lshlrev_b32 v144, 16, v152
  v_and_b32 v145, 0xffff0000, v152
  v_lshlrev_b32 v146, 16, v153
  v_and_b32 v147, 0xffff0000, v153
  v_lshlrev_b32 v148, 16, v154
  v_and_b32 v149, 0xffff0000, v154
  v_lshlrev_b32 v150, 16, v155
  v_and_b32 v151, 0xffff0000, v155
  buffer_load_dwordx4 v[80:83], v2, s[24:27], s54 offen offset:0 sc1 nt
  buffer_load_dwordx4 v[84:87], v2, s[24:27], s54 offen offset:1024 sc1 nt
  buffer_load_dwordx4 v[88:91], v2, s[24:27], s54 offen offset:2048 sc1 nt
  buffer_load_dwordx4 v[92:95], v2, s[24:27], s54 offen offset:3072 sc1 nt
  buffer_load_dwordx4 v[96:99], v3, s[24:27], s54 offen offset:0 sc1 nt
  buffer_load_dwordx4 v[100:103], v3, s[24:27], s54 offen offset:1024 sc1 nt
  buffer_load_dwordx4 v[104:107], v3, s[24:27], s54 offen offset:2048 sc1 nt
  buffer_load_dwordx4 v[108:111], v3, s[24:27], s54 offen offset:3072 sc1 nt
  v_max3_f32 v178, v144, v145, v146
  v_max3_f32 v179, v147, v148, v149
  v_max3_f32 v180, v150, v151, v176
  v_max3_f32 v178, v178, v179, v180
  v_mul_f32 v179, s57, v178
  v_fma_f32 v180, v176, s57, -v179
  v_mov_b32 v176, v178
  v_exp_f32 v180, v180
  v_fma_f32 v144, v144, s57, -v179
  v_fma_f32 v145, v145, s57, -v179
  v_fma_f32 v146, v146, s57, -v179
  v_fma_f32 v147, v147, s57, -v179
  v_fma_f32 v148, v148, s57, -v179
  v_fma_f32 v149, v149, s57, -v179
  v_fma_f32 v150, v150, s57, -v179
  v_fma_f32 v151, v151, s57, -v179
  v_exp_f32 v144, v144
  v_exp_f32 v145, v145
  v_exp_f32 v146, v146
  v_exp_f32 v147, v147
  v_exp_f32 v148, v148
  v_exp_f32 v149, v149
  v_exp_f32 v150, v150
  v_exp_f32 v151, v151
  v_mul_f32 v177, v177, v180
  v_mul_f32 v168, v168, v180
  v_mul_f32 v169, v169, v180
  v_mul_f32 v170, v170, v180
  v_mul_f32 v171, v171, v180
  v_mul_f32 v172, v172, v180
  v_mul_f32 v173, v173, v180
  v_mul_f32 v174, v174, v180
  v_mul_f32 v175, v175, v180
  v_cvt_pk_bf16_f32 v152, v144, 0
  v_cvt_pk_bf16_f32 v160, 0, v144
  v_cvt_pk_bf16_f32 v153, v145, 0
  v_cvt_pk_bf16_f32 v161, 0, v145
  v_cvt_pk_bf16_f32 v154, v146, 0
  v_cvt_pk_bf16_f32 v162, 0, v146
  v_cvt_pk_bf16_f32 v155, v147, 0
  v_cvt_pk_bf16_f32 v163, 0, v147
  v_cvt_pk_bf16_f32 v156, v148, 0
  v_cvt_pk_bf16_f32 v164, 0, v148
  v_cvt_pk_bf16_f32 v157, v149, 0
  v_cvt_pk_bf16_f32 v165, 0, v149
  v_cvt_pk_bf16_f32 v158, v150, 0
  v_cvt_pk_bf16_f32 v166, 0, v150
  v_cvt_pk_bf16_f32 v159, v151, 0
  v_cvt_pk_bf16_f32 v167, 0, v151
  v_add_f32 v178, v144, v145
  v_add_f32 v179, v146, v147
  v_add_f32 v181, v148, v149
  v_add_f32 v182, v150, v151
  v_add_f32 v178, v178, v179
  v_add_f32 v181, v181, v182
  v_add_f32 v178, v178, v181
  v_add_f32 v177, v177, v178
  s_waitcnt vmcnt(16)
  v_dot2_f32_bf16 v168, v112, v152, v168
  v_dot2_f32_bf16 v169, v112, v160, v169
  v_dot2_f32_bf16 v170, v113, v152, v170
  v_dot2_f32_bf16 v171, v113, v160, v171
  v_dot2_f32_bf16 v172, v114, v152, v172
  v_dot2_f32_bf16 v173, v114, v160, v173
  v_dot2_f32_bf16 v174, v115, v152, v174
  v_dot2_f32_bf16 v175, v115, v160, v175
  v_dot2_f32_bf16 v168, v116, v153, v168
  v_dot2_f32_bf16 v169, v116, v161, v169
  v_dot2_f32_bf16 v170, v117, v153, v170
  v_dot2_f32_bf16 v171, v117, v161, v171
  v_dot2_f32_bf16 v172, v118, v153, v172
  v_dot2_f32_bf16 v173, v118, v161, v173
  v_dot2_f32_bf16 v174, v119, v153, v174
  v_dot2_f32_bf16 v175, v119, v161, v175
  v_dot2_f32_bf16 v168, v120, v154, v168
  v_dot2_f32_bf16 v169, v120, v162, v169
  v_dot2_f32_bf16 v170, v121, v154, v170
  v_dot2_f32_bf16 v171, v121, v162, v171
  v_dot2_f32_bf16 v172, v122, v154, v172
  v_dot2_f32_bf16 v173, v122, v162, v173
  v_dot2_f32_bf16 v174, v123, v154, v174
  v_dot2_f32_bf16 v175, v123, v162, v175
  v_dot2_f32_bf16 v168, v124, v155, v168
  v_dot2_f32_bf16 v169, v124, v163, v169
  v_dot2_f32_bf16 v170, v125, v155, v170
  v_dot2_f32_bf16 v171, v125, v163, v171
  v_dot2_f32_bf16 v172, v126, v155, v172
  v_dot2_f32_bf16 v173, v126, v163, v173
  v_dot2_f32_bf16 v174, v127, v155, v174
  v_dot2_f32_bf16 v175, v127, v163, v175
  v_dot2_f32_bf16 v168, v128, v156, v168
  v_dot2_f32_bf16 v169, v128, v164, v169
  v_dot2_f32_bf16 v170, v129, v156, v170
  v_dot2_f32_bf16 v171, v129, v164, v171
  v_dot2_f32_bf16 v172, v130, v156, v172
  v_dot2_f32_bf16 v173, v130, v164, v173
  v_dot2_f32_bf16 v174, v131, v156, v174
  v_dot2_f32_bf16 v175, v131, v164, v175
  v_dot2_f32_bf16 v168, v132, v157, v168
  v_dot2_f32_bf16 v169, v132, v165, v169
  v_dot2_f32_bf16 v170, v133, v157, v170
  v_dot2_f32_bf16 v171, v133, v165, v171
  v_dot2_f32_bf16 v172, v134, v157, v172
  v_dot2_f32_bf16 v173, v134, v165, v173
  v_dot2_f32_bf16 v174, v135, v157, v174
  v_dot2_f32_bf16 v175, v135, v165, v175
  v_dot2_f32_bf16 v168, v136, v158, v168
  v_dot2_f32_bf16 v169, v136, v166, v169
  v_dot2_f32_bf16 v170, v137, v158, v170
  v_dot2_f32_bf16 v171, v137, v166, v171
  v_dot2_f32_bf16 v172, v138, v158, v172
  v_dot2_f32_bf16 v173, v138, v166, v173
  v_dot2_f32_bf16 v174, v139, v158, v174
  v_dot2_f32_bf16 v175, v139, v166, v175
  v_dot2_f32_bf16 v168, v140, v159, v168
  v_dot2_f32_bf16 v169, v140, v167, v169
  v_dot2_f32_bf16 v170, v141, v159, v170
  v_dot2_f32_bf16 v171, v141, v167, v171
  v_dot2_f32_bf16 v172, v142, v159, v172
  v_dot2_f32_bf16 v173, v142, v167, v173
  v_dot2_f32_bf16 v174, v143, v159, v174
  v_dot2_f32_bf16 v175, v143, v167, v175
  s_cmp_ge_u32 s54, 0x400000
  s_cbranch_scc1 L1_done
  s_branch L1_loop
L1_done:
  s_waitcnt vmcnt(0) lgkmcnt(0)
  s_lshl_b32 s55, s52, 10
  buffer_load_dwordx4 v[16:19], v2, s[32:35], s55 offen
  s_add_u32 s55, s55, 8192
  buffer_load_dwordx4 v[20:23], v2, s[32:35], s55 offen
  s_add_u32 s55, s55, 8192
  buffer_load_dwordx4 v[24:27], v2, s[32:35], s55 offen
  s_add_u32 s55, s55, 8192
  buffer_load_dwordx4 v[28:31], v2, s[32:35], s55 offen
  s_add_u32 s55, s55, 8192
  buffer_load_dwordx4 v[32:35], v2, s[32:35], s55 offen
  s_add_u32 s55, s55, 8192
  buffer_load_dwordx4 v[36:39], v2, s[32:35], s55 offen
  s_add_u32 s55, s55, 8192
  buffer_load_dwordx4 v[40:43], v2, s[32:35], s55 offen
  s_add_u32 s55, s55, 8192
  buffer_load_dwordx4 v[44:47], v2, s[32:35], s55 offen
  s_add_u32 s55, s55, 8192
  buffer_load_dwordx4 v[48:51], v2, s[32:35], s55 offen
  s_add_u32 s55, s55, 8192
  buffer_load_dwordx4 v[52:55], v2, s[32:35], s55 offen
  s_add_u32 s55, s55, 8192
  buffer_load_dwordx4 v[56:59], v2, s[32:35], s55 offen
  s_add_u32 s55, s55, 8192
  buffer_load_dwordx4 v[60:63], v2, s[32:35], s55 offen
  s_add_u32 s55, s55, 8192
  buffer_load_dwordx4 v[64:67], v2, s[32:35], s55 offen
  s_add_u32 s55, s55, 8192
  buffer_load_dwordx4 v[68:71], v2, s[32:35], s55 offen
  s_add_u32 s55, s55, 8192
  buffer_load_dwordx4 v[72:75], v2, s[32:35], s55 offen
  s_add_u32 s55, s55, 8192
  buffer_load_dwordx4 v[76:79], v2, s[32:35], s55 offen
  s_add_u32 s55, s55, 8192
  v_lshlrev_b32 v15, 5, v0
  ds_write_b128 v15, v[168:171] offset:2048
  ds_write_b128 v15, v[172:175] offset:2064
  v_and_b32 v14, 15, v0
  v_cmp_eq_u32 vcc, 0, v14
  v_lshrrev_b32 v15, 4, v0
  v_lshlrev_b32 v15, 3, v15
  s_and_saveexec_b64 s[60:61], vcc
  ds_write_b64 v15, v[176:177] offset:55808
  s_mov_b64 exec, s[60:61]
  s_waitcnt lgkmcnt(0)
  s_barrier
  s_cmp_ge_u32 s52, 2
  s_cbranch_scc1 L1_skipc
  v_mov_b32 v15, 0
  ds_read_b64 v[80:81], v15 offset:55808
  ds_read_b64 v[82:83], v15 offset:55816
  ds_read_b64 v[84:85], v15 offset:55824
  ds_read_b64 v[86:87], v15 offset:55832
  ds_read_b64 v[88:89], v15 offset:55840
  ds_read_b64 v[90:91], v15 offset:55848
  ds_read_b64 v[92:93], v15 offset:55856
  ds_read_b64 v[94:95], v15 offset:55864
  ds_read_b64 v[96:97], v15 offset:55872
  ds_read_b64 v[98:99], v15 offset:55880
  ds_read_b64 v[100:101], v15 offset:55888
  ds_read_b64 v[102:103], v15 offset:55896
  ds_read_b64 v[104:105], v15 offset:55904
  ds_read_b64 v[106:107], v15 offset:55912
  ds_read_b64 v[108:109], v15 offset:55920
  ds_read_b64 v[110:111], v15 offset:55928
  ds_read_b64 v[112:113], v15 offset:55936
  ds_read_b64 v[114:115], v15 offset:55944
  ds_read_b64 v[116:117], v15 offset:55952
  ds_read_b64 v[118:119], v15 offset:55960
  ds_read_b64 v[120:121], v15 offset:55968
  ds_read_b64 v[122:123], v15 offset:55976
  ds_read_b64 v[124:125], v15 offset:55984
  ds_read_b64 v[126:127], v15 offset:55992
  ds_read_b64 v[128:129], v15 offset:56000
  ds_read_b64 v[130:131], v15 offset:56008
  ds_read_b64 v[132:133], v15 offset:56016
  ds_read_b64 v[134:135], v15 offset:56024
  ds_read_b64 v[136:137], v15 offset:56032
  ds_read_b64 v[138:139], v15 offset:56040
  ds_read_b64 v[140:141], v15 offset:56048
  ds_read_b64 v[142:143], v15 offset:56056
  v_lshlrev_b32 v15, 2, v0
  s_waitcnt lgkmcnt(0)
  v_max3_f32 v178, v80, v82, v84
  v_max3_f32 v178, v178, v86, v88
  v_max3_f32 v178, v178, v90, v92
  v_max3_f32 v178, v178, v94, v96
  v_max3_f32 v178, v178, v98, v100
  v_max3_f32 v178, v178, v102, v104
  v_max3_f32 v178, v178, v106, v108
  v_max3_f32 v178, v178, v110, v112
  v_max3_f32 v178, v178, v114, v116
  v_max3_f32 v178, v178, v118, v120
  v_max3_f32 v178, v178, v122, v124
  v_max3_f32 v178, v178, v126, v128
  v_max3_f32 v178, v178, v130, v132
  v_max3_f32 v178, v178, v134, v136
  v_max3_f32 v178, v178, v138, v140
  v_max_f32 v178, v178, v142
  v_mul_f32 v179, s57, v178
  v_fma_f32 v80, v80, s57, -v179
  v_fma_f32 v82, v82, s57, -v179
  v_fma_f32 v84, v84, s57, -v179
  v_fma_f32 v86, v86, s57, -v179
  v_fma_f32 v88, v88, s57, -v179
  v_fma_f32 v90, v90, s57, -v179
  v_fma_f32 v92, v92, s57, -v179
  v_fma_f32 v94, v94, s57, -v179
  v_fma_f32 v96, v96, s57, -v179
  v_fma_f32 v98, v98, s57, -v179
  v_fma_f32 v100, v100, s57, -v179
  v_fma_f32 v102, v102, s57, -v179
  v_fma_f32 v104, v104, s57, -v179
  v_fma_f32 v106, v106, s57, -v179
  v_fma_f32 v108, v108, s57, -v179
  v_fma_f32 v110, v110, s57, -v179
  v_fma_f32 v112, v112, s57, -v179
  v_fma_f32 v114, v114, s57, -v179
  v_fma_f32 v116, v116, s57, -v179
  v_fma_f32 v118, v118, s57, -v179
  v_fma_f32 v120, v120, s57, -v179
  v_fma_f32 v122, v122, s57, -v179
  v_fma_f32 v124, v124, s57, -v179
  v_fma_f32 v126, v126, s57, -v179
  v_fma_f32 v128, v128, s57, -v179
  v_fma_f32 v130, v130, s57, -v179
  v_fma_f32 v132, v132, s57, -v179
  v_fma_f32 v134, v134, s57, -v179
  v_fma_f32 v136, v136, s57, -v179
  v_fma_f32 v138, v138, s57, -v179
  v_fma_f32 v140, v140, s57, -v179
  v_fma_f32 v142, v142, s57, -v179
  v_exp_f32 v80, v80
  v_exp_f32 v82, v82
  v_exp_f32 v84, v84
  v_exp_f32 v86, v86
  v_exp_f32 v88, v88
  v_exp_f32 v90, v90
  v_exp_f32 v92, v92
  v_exp_f32 v94, v94
  v_exp_f32 v96, v96
  v_exp_f32 v98, v98
  v_exp_f32 v100, v100
  v_exp_f32 v102, v102
  v_exp_f32 v104, v104
  v_exp_f32 v106, v106
  v_exp_f32 v108, v108
  v_exp_f32 v110, v110
  v_exp_f32 v112, v112
  v_exp_f32 v114, v114
  v_exp_f32 v116, v116
  v_exp_f32 v118, v118
  v_exp_f32 v120, v120
  v_exp_f32 v122, v122
  v_exp_f32 v124, v124
  v_exp_f32 v126, v126
  v_exp_f32 v128, v128
  v_exp_f32 v130, v130
  v_exp_f32 v132, v132
  v_exp_f32 v134, v134
  v_exp_f32 v136, v136
  v_exp_f32 v138, v138
  v_exp_f32 v140, v140
  v_exp_f32 v142, v142
  ds_read_b32 v144, v15 offset:2048
  ds_read_b32 v145, v15 offset:2560
  ds_read_b32 v146, v15 offset:3072
  ds_read_b32 v147, v15 offset:3584
  ds_read_b32 v148, v15 offset:4096
  ds_read_b32 v149, v15 offset:4608
  ds_read_b32 v150, v15 offset:5120
  ds_read_b32 v151, v15 offset:5632
  ds_read_b32 v152, v15 offset:6144
  ds_read_b32 v153, v15 offset:6656
  ds_read_b32 v154, v15 offset:7168
  ds_read_b32 v155, v15 offset:7680
  ds_read_b32 v156, v15 offset:8192
  ds_read_b32 v157, v15 offset:8704
  ds_read_b32 v158, v15 offset:9216
  ds_read_b32 v159, v15 offset:9728
  ds_read_b32 v160, v15 offset:10240
  ds_read_b32 v161, v15 offset:10752
  ds_read_b32 v162, v15 offset:11264
  ds_read_b32 v163, v15 offset:11776
  ds_read_b32 v164, v15 offset:12288
  ds_read_b32 v165, v15 offset:12800
  ds_read_b32 v166, v15 offset:13312
  ds_read_b32 v167, v15 offset:13824
  ds_read_b32 v168, v15 offset:14336
  ds_read_b32 v169, v15 offset:14848
  ds_read_b32 v170, v15 offset:15360
  ds_read_b32 v171, v15 offset:15872
  ds_read_b32 v172, v15 offset:16384
  ds_read_b32 v173, v15 offset:16896
  ds_read_b32 v174, v15 offset:17408
  ds_read_b32 v175, v15 offset:17920
  v_mov_b32 v180, 0
  v_fmac_f32 v180, v80, v81
  v_fmac_f32 v180, v82, v83
  v_fmac_f32 v180, v84, v85
  v_fmac_f32 v180, v86, v87
  v_fmac_f32 v180, v88, v89
  v_fmac_f32 v180, v90, v91
  v_fmac_f32 v180, v92, v93
  v_fmac_f32 v180, v94, v95
  v_fmac_f32 v180, v96, v97
  v_fmac_f32 v180, v98, v99
  v_fmac_f32 v180, v100, v101
  v_fmac_f32 v180, v102, v103
  v_fmac_f32 v180, v104, v105
  v_fmac_f32 v180, v106, v107
  v_fmac_f32 v180, v108, v109
  v_fmac_f32 v180, v110, v111
  v_fmac_f32 v180, v112, v113
  v_fmac_f32 v180, v114, v115
  v_fmac_f32 v180, v116, v117
  v_fmac_f32 v180, v118, v119
  v_fmac_f32 v180, v120, v121
  v_fmac_f32 v180, v122, v123
  v_fmac_f32 v180, v124, v125
  v_fmac_f32 v180, v126, v127
  v_fmac_f32 v180, v128, v129
  v_fmac_f32 v180, v130, v131
  v_fmac_f32 v180, v132, v133
  v_fmac_f32 v180, v134, v135
  v_fmac_f32 v180, v136, v137
  v_fmac_f32 v180, v138, v139
  v_fmac_f32 v180, v140, v141
  v_fmac_f32 v180, v142, v143
  v_mov_b32 v181, 0
  s_waitcnt lgkmcnt(0)
  v_fmac_f32 v181, v80, v144
  v_fmac_f32 v181, v82, v145
  v_fmac_f32 v181, v84, v146
  v_fmac_f32 v181, v86, v147
  v_fmac_f32 v181, v88, v148
  v_fmac_f32 v181, v90, v149
  v_fmac_f32 v181, v92, v150
  v_fmac_f32 v181, v94, v151
  v_fmac_f32 v181, v96, v152
  v_fmac_f32 v181, v98, v153
  v_fmac_f32 v181, v100, v154
  v_fmac_f32 v181, v102, v155
  v_fmac_f32 v181, v104, v156
  v_fmac_f32 v181, v106, v157
  v_fmac_f32 v181, v108, v158
  v_fmac_f32 v181, v110, v159
  v_fmac_f32 v181, v112, v160
  v_fmac_f32 v181, v114, v161
  v_fmac_f32 v181, v116, v162
  v_fmac_f32 v181, v118, v163
  v_fmac_f32 v181, v120, v164
  v_fmac_f32 v181, v122, v165
  v_fmac_f32 v181, v124, v166
  v_fmac_f32 v181, v126, v167
  v_fmac_f32 v181, v128, v168
  v_fmac_f32 v181, v130, v169
  v_fmac_f32 v181, v132, v170
  v_fmac_f32 v181, v134, v171
  v_fmac_f32 v181, v136, v172
  v_fmac_f32 v181, v138, v173
  v_fmac_f32 v181, v140, v174
  v_fmac_f32 v181, v142, v175
  s_lshl_b32 s55, s2, 10
  buffer_store_dword v181, v15, s[40:43], s55 offen sc1
  v_mov_b32 v179, v180
  v_cmp_eq_u32 vcc, 0, v0
  s_and_saveexec_b64 s[60:61], vcc
  buffer_store_dwordx2 v[178:179], v15, s[40:43], s55 offen offset:512 sc1
  s_mov_b64 exec, s[60:61]
  s_waitcnt vmcnt(0)
L1_skipc:
  s_barrier
  s_cmp_lg_u32 s52, 0
  s_cbranch_scc1 L1_skipa
  s_and_b32 s55, s48, 3
  s_lshl_b32 s62, s55, 3
  s_lshl_b32 s55, 1, s62
  v_mov_b32 v14, s55
  v_mov_b32 v15, 0
  s_and_b32 s55, s48, 0xfc
  s_mov_b32 s63, 0
  v_cmp_eq_u32 vcc, 0, v0
  s_and_saveexec_b64 s[60:61], vcc
  buffer_atomic_add v14, v15, s[44:47], s55 offen offset:0 sc0 sc1
L_zfpoll:
  buffer_load_dword v13, v15, s[44:47], 0 offen offset:192 sc1
  s_waitcnt vmcnt(0)
  v_readfirstlane_b32 s55, v13
  s_cmp_lg_u32 s55, 0
  s_cbranch_scc1 L_zfok
  s_sleep 2
  s_add_u32 s63, s63, 1
  s_cmp_lt_u32 s63, 400000
  s_cbranch_scc1 L_zfpoll
L_zfok:
  v_lshrrev_b32 v14, s62, v14
  v_and_b32 v14, 0xff, v14
  ds_write_b32 v15, v14 offset:56320
  s_mov_b64 exec, s[60:61]
  s_waitcnt lgkmcnt(0)
L1_skipa:
  s_barrier
  v_mov_b32 v15, 0
  ds_read_b32 v14, v15 offset:56320
  s_waitcnt lgkmcnt(0)
  v_readfirstlane_b32 s55, v14
  s_cmp_lg_u32 s55, 3
  s_cbranch_scc1 L_stageC
  s_cmp_ge_u32 s52, 2
  s_cbranch_scc1 L1_skipf
  s_lshl_b32 s55, s48, 12
  v_lshlrev_b32 v15, 2, v0
  v_mov_b32 v14, 0
  buffer_load_dword v144, v15, s[40:43], s55 offen offset:0 sc1
  buffer_load_dwordx2 v[148:149], v14, s[40:43], s55 offen offset:512 sc1
  buffer_load_dword v145, v15, s[40:43], s55 offen offset:1024 sc1
  buffer_load_dwordx2 v[150:151], v14, s[40:43], s55 offen offset:1536 sc1
  buffer_load_dword v146, v15, s[40:43], s55 offen offset:2048 sc1
  buffer_load_dwordx2 v[152:153], v14, s[40:43], s55 offen offset:2560 sc1
  buffer_load_dword v147, v15, s[40:43], s55 offen offset:3072 sc1
  buffer_load_dwordx2 v[154:155], v14, s[40:43], s55 offen offset:3584 sc1
  s_waitcnt vmcnt(0)
  v_max3_f32 v178, v148, v150, v152
  v_max_f32 v178, v178, v154
  v_mul_f32 v179, s57, v178
  v_fma_f32 v148, v148, s57, -v179
  v_fma_f32 v150, v150, s57, -v179
  v_fma_f32 v152, v152, s57, -v179
  v_fma_f32 v154, v154, s57, -v179
  v_exp_f32 v148, v148
  v_exp_f32 v150, v150
  v_exp_f32 v152, v152
  v_exp_f32 v154, v154
  s_nop 0
  v_mul_f32 v180, v148, v149
  v_mul_f32 v181, v148, v144
  v_fmac_f32 v180, v150, v151
  v_fmac_f32 v181, v150, v145
  v_fmac_f32 v180, v152, v153
  v_fmac_f32 v181, v152, v146
  v_fmac_f32 v180, v154, v155
  v_fmac_f32 v181, v154, v147
  v_rcp_f32 v182, v180
  s_nop 0
  v_fma_f32 v183, -v180, v182, 2.0
  v_mul_f32 v182, v182, v183
  v_mul_f32 v181, v181, v182
  v_cvt_pk_bf16_f32 v181, v181, 0
  ds_write_b32 v15, v181 offset:56576
  s_waitcnt lgkmcnt(0)
L1_skipf:
  s_barrier
  s_lshl_b32 s55, s52, 2
  v_mov_b32 v15, s55
  ds_read_b32 v144, v15 offset:56576
  ds_read_b32 v145, v15 offset:56608
  ds_read_b32 v146, v15 offset:56640
  ds_read_b32 v147, v15 offset:56672
  ds_read_b32 v148, v15 offset:56704
  ds_read_b32 v149, v15 offset:56736
  ds_read_b32 v150, v15 offset:56768
  ds_read_b32 v151, v15 offset:56800
  ds_read_b32 v152, v15 offset:56832
  ds_read_b32 v153, v15 offset:56864
  ds_read_b32 v154, v15 offset:56896
  ds_read_b32 v155, v15 offset:56928
  ds_read_b32 v156, v15 offset:56960
  ds_read_b32 v157, v15 offset:56992
  ds_read_b32 v158, v15 offset:57024
  ds_read_b32 v159, v15 offset:57056
  v_mov_b32 v168, 0
  v_mov_b32 v169, 0
  v_mov_b32 v170, 0
  v_mov_b32 v171, 0
  v_mov_b32 v172, 0
  v_mov_b32 v173, 0
  v_mov_b32 v174, 0
  v_mov_b32 v175, 0
  s_waitcnt lgkmcnt(0) vmcnt(0)
  v_lshlrev_b32 v178, 16, v144
  v_dot2_f32_bf16 v168, v16, v144, v168
  v_dot2_f32_bf16 v170, v17, v144, v170
  v_dot2_f32_bf16 v172, v18, v144, v172
  v_dot2_f32_bf16 v174, v19, v144, v174
  v_dot2_f32_bf16 v169, v16, v178, v169
  v_dot2_f32_bf16 v171, v17, v178, v171
  v_dot2_f32_bf16 v173, v18, v178, v173
  v_dot2_f32_bf16 v175, v19, v178, v175
  s_nop 2
  v_lshlrev_b32 v178, 16, v145
  v_dot2_f32_bf16 v168, v20, v145, v168
  v_dot2_f32_bf16 v170, v21, v145, v170
  v_dot2_f32_bf16 v172, v22, v145, v172
  v_dot2_f32_bf16 v174, v23, v145, v174
  v_dot2_f32_bf16 v169, v20, v178, v169
  v_dot2_f32_bf16 v171, v21, v178, v171
  v_dot2_f32_bf16 v173, v22, v178, v173
  v_dot2_f32_bf16 v175, v23, v178, v175
  s_nop 2
  v_lshlrev_b32 v178, 16, v146
  v_dot2_f32_bf16 v168, v24, v146, v168
  v_dot2_f32_bf16 v170, v25, v146, v170
  v_dot2_f32_bf16 v172, v26, v146, v172
  v_dot2_f32_bf16 v174, v27, v146, v174
  v_dot2_f32_bf16 v169, v24, v178, v169
  v_dot2_f32_bf16 v171, v25, v178, v171
  v_dot2_f32_bf16 v173, v26, v178, v173
  v_dot2_f32_bf16 v175, v27, v178, v175
  s_nop 2
  v_lshlrev_b32 v178, 16, v147
  v_dot2_f32_bf16 v168, v28, v147, v168
  v_dot2_f32_bf16 v170, v29, v147, v170
  v_dot2_f32_bf16 v172, v30, v147, v172
  v_dot2_f32_bf16 v174, v31, v147, v174
  v_dot2_f32_bf16 v169, v28, v178, v169
  v_dot2_f32_bf16 v171, v29, v178, v171
  v_dot2_f32_bf16 v173, v30, v178, v173
  v_dot2_f32_bf16 v175, v31, v178, v175
  s_nop 2
  v_lshlrev_b32 v178, 16, v148
  v_dot2_f32_bf16 v168, v32, v148, v168
  v_dot2_f32_bf16 v170, v33, v148, v170
  v_dot2_f32_bf16 v172, v34, v148, v172
  v_dot2_f32_bf16 v174, v35, v148, v174
  v_dot2_f32_bf16 v169, v32, v178, v169
  v_dot2_f32_bf16 v171, v33, v178, v171
  v_dot2_f32_bf16 v173, v34, v178, v173
  v_dot2_f32_bf16 v175, v35, v178, v175
  s_nop 2
  v_lshlrev_b32 v178, 16, v149
  v_dot2_f32_bf16 v168, v36, v149, v168
  v_dot2_f32_bf16 v170, v37, v149, v170
  v_dot2_f32_bf16 v172, v38, v149, v172
  v_dot2_f32_bf16 v174, v39, v149, v174
  v_dot2_f32_bf16 v169, v36, v178, v169
  v_dot2_f32_bf16 v171, v37, v178, v171
  v_dot2_f32_bf16 v173, v38, v178, v173
  v_dot2_f32_bf16 v175, v39, v178, v175
  s_nop 2
  v_lshlrev_b32 v178, 16, v150
  v_dot2_f32_bf16 v168, v40, v150, v168
  v_dot2_f32_bf16 v170, v41, v150, v170
  v_dot2_f32_bf16 v172, v42, v150, v172
  v_dot2_f32_bf16 v174, v43, v150, v174
  v_dot2_f32_bf16 v169, v40, v178, v169
  v_dot2_f32_bf16 v171, v41, v178, v171
  v_dot2_f32_bf16 v173, v42, v178, v173
  v_dot2_f32_bf16 v175, v43, v178, v175
  s_nop 2
  v_lshlrev_b32 v178, 16, v151
  v_dot2_f32_bf16 v168, v44, v151, v168
  v_dot2_f32_bf16 v170, v45, v151, v170
  v_dot2_f32_bf16 v172, v46, v151, v172
  v_dot2_f32_bf16 v174, v47, v151, v174
  v_dot2_f32_bf16 v169, v44, v178, v169
  v_dot2_f32_bf16 v171, v45, v178, v171
  v_dot2_f32_bf16 v173, v46, v178, v173
  v_dot2_f32_bf16 v175, v47, v178, v175
  s_nop 2
  v_lshlrev_b32 v178, 16, v152
  v_dot2_f32_bf16 v168, v48, v152, v168
  v_dot2_f32_bf16 v170, v49, v152, v170
  v_dot2_f32_bf16 v172, v50, v152, v172
  v_dot2_f32_bf16 v174, v51, v152, v174
  v_dot2_f32_bf16 v169, v48, v178, v169
  v_dot2_f32_bf16 v171, v49, v178, v171
  v_dot2_f32_bf16 v173, v50, v178, v173
  v_dot2_f32_bf16 v175, v51, v178, v175
  s_nop 2
  v_lshlrev_b32 v178, 16, v153
  v_dot2_f32_bf16 v168, v52, v153, v168
  v_dot2_f32_bf16 v170, v53, v153, v170
  v_dot2_f32_bf16 v172, v54, v153, v172
  v_dot2_f32_bf16 v174, v55, v153, v174
  v_dot2_f32_bf16 v169, v52, v178, v169
  v_dot2_f32_bf16 v171, v53, v178, v171
  v_dot2_f32_bf16 v173, v54, v178, v173
  v_dot2_f32_bf16 v175, v55, v178, v175
  s_nop 2
  v_lshlrev_b32 v178, 16, v154
  v_dot2_f32_bf16 v168, v56, v154, v168
  v_dot2_f32_bf16 v170, v57, v154, v170
  v_dot2_f32_bf16 v172, v58, v154, v172
  v_dot2_f32_bf16 v174, v59, v154, v174
  v_dot2_f32_bf16 v169, v56, v178, v169
  v_dot2_f32_bf16 v171, v57, v178, v171
  v_dot2_f32_bf16 v173, v58, v178, v173
  v_dot2_f32_bf16 v175, v59, v178, v175
  s_nop 2
  v_lshlrev_b32 v178, 16, v155
  v_dot2_f32_bf16 v168, v60, v155, v168
  v_dot2_f32_bf16 v170, v61, v155, v170
  v_dot2_f32_bf16 v172, v62, v155, v172
  v_dot2_f32_bf16 v174, v63, v155, v174
  v_dot2_f32_bf16 v169, v60, v178, v169
  v_dot2_f32_bf16 v171, v61, v178, v171
  v_dot2_f32_bf16 v173, v62, v178, v173
  v_dot2_f32_bf16 v175, v63, v178, v175
  s_nop 2
  v_lshlrev_b32 v178, 16, v156
  v_dot2_f32_bf16 v168, v64, v156, v168
  v_dot2_f32_bf16 v170, v65, v156, v170
  v_dot2_f32_bf16 v172, v66, v156, v172
  v_dot2_f32_bf16 v174, v67, v156, v174
  v_dot2_f32_bf16 v169, v64, v178, v169
  v_dot2_f32_bf16 v171, v65, v178, v171
  v_dot2_f32_bf16 v173, v66, v178, v173
  v_dot2_f32_bf16 v175, v67, v178, v175
  s_nop 2
  v_lshlrev_b32 v178, 16, v157
  v_dot2_f32_bf16 v168, v68, v157, v168
  v_dot2_f32_bf16 v170, v69, v157, v170
  v_dot2_f32_bf16 v172, v70, v157, v172
  v_dot2_f32_bf16 v174, v71, v157, v174
  v_dot2_f32_bf16 v169, v68, v178, v169
  v_dot2_f32_bf16 v171, v69, v178, v171
  v_dot2_f32_bf16 v173, v70, v178, v173
  v_dot2_f32_bf16 v175, v71, v178, v175
  s_nop 2
  v_lshlrev_b32 v178, 16, v158
  v_dot2_f32_bf16 v168, v72, v158, v168
  v_dot2_f32_bf16 v170, v73, v158, v170
  v_dot2_f32_bf16 v172, v74, v158, v172
  v_dot2_f32_bf16 v174, v75, v158, v174
  v_dot2_f32_bf16 v169, v72, v178, v169
  v_dot2_f32_bf16 v171, v73, v178, v171
  v_dot2_f32_bf16 v173, v74, v178, v173
  v_dot2_f32_bf16 v175, v75, v178, v175
  s_nop 2
  v_lshlrev_b32 v178, 16, v159
  v_dot2_f32_bf16 v168, v76, v159, v168
  v_dot2_f32_bf16 v170, v77, v159, v170
  v_dot2_f32_bf16 v172, v78, v159, v172
  v_dot2_f32_bf16 v174, v79, v159, v174
  v_dot2_f32_bf16 v169, v76, v178, v169
  v_dot2_f32_bf16 v171, v77, v178, v171
  v_dot2_f32_bf16 v173, v78, v178, v173
  v_dot2_f32_bf16 v175, v79, v178, v175
  s_nop 2
  v_lshlrev_b32 v15, 5, v0
  ds_write_b128 v15, v[168:171] offset:2048
  ds_write_b128 v15, v[172:175] offset:2064
  s_waitcnt lgkmcnt(0)
  s_barrier
  v_lshlrev_b32 v15, 2, v0
  ds_read_b32 v144, v15 offset:2048
  ds_read_b32 v145, v15 offset:4096
  ds_read_b32 v146, v15 offset:6144
  ds_read_b32 v147, v15 offset:8192
  ds_read_b32 v148, v15 offset:10240
  ds_read_b32 v149, v15 offset:12288
  ds_read_b32 v150, v15 offset:14336
  ds_read_b32 v151, v15 offset:16384
  s_waitcnt lgkmcnt(0)
  v_add_f32 v144, v144, v148
  v_add_f32 v145, v145, v149
  v_add_f32 v146, v146, v150
  v_add_f32 v147, v147, v151
  v_add_f32 v144, v144, v146
  v_add_f32 v145, v145, v147
  v_add_f32 v144, v144, v145
  s_lshl_b32 s55, s50, 11
  s_add_u32 s55, s55, 524288
  buffer_atomic_add_f32 v144, v15, s[40:43], s55 offen sc1
  s_waitcnt vmcnt(0)
  s_barrier
  s_cmp_lg_u32 s52, 0
  s_cbranch_scc1 L_stageC
  v_mov_b32 v14, 1
  v_mov_b32 v15, 0
  v_cmp_eq_u32 vcc, 0, v0
  s_and_saveexec_b64 s[60:61], vcc
  buffer_atomic_add v14, v15, s[44:47], 0 offen offset:128 sc1
  s_mov_b64 exec, s[60:61]
L_stageC:
  s_cmp_ge_u32 s49, 56
  s_cbranch_scc1 L_end
  v_mov_b32 v15, 0
  s_mov_b32 s63, 0
L_poll:
  buffer_load_dword v14, v15, s[44:47], 0 offen offset:128 sc1
  s_waitcnt vmcnt(0)
  v_readfirstlane_b32 s55, v14
  s_cmp_ge_u32 s55, 64
  s_cbranch_scc1 L_pollok
  s_sleep 1
  s_add_u32 s63, s63, 1
  s_cmp_lt_u32 s63, 400000
  s_cbranch_scc1 L_poll
L_pollok:
  v_lshlrev_b32 v15, 5, v1
  s_mov_b32 s55, 524288
  buffer_load_dwordx4 v[16:19], v15, s[40:43], s55 offen offset:0 sc1
  buffer_load_dwordx4 v[20:23], v15, s[40:43], s55 offen offset:16 sc1
  buffer_load_dwordx4 v[24:27], v15, s[40:43], s55 offen offset:2048 sc1
  buffer_load_dwordx4 v[28:31], v15, s[40:43], s55 offen offset:2064 sc1
  v_lshlrev_b32 v48, 16, v240
  v_and_b32 v49, 0xffff0000, v240
  v_lshlrev_b32 v50, 16, v241
  v_and_b32 v51, 0xffff0000, v241
  v_lshlrev_b32 v52, 16, v242
  v_and_b32 v53, 0xffff0000, v242
  v_lshlrev_b32 v54, 16, v243
  v_and_b32 v55, 0xffff0000, v243
  v_lshlrev_b32 v56, 16, v244
  v_and_b32 v57, 0xffff0000, v244
  v_lshlrev_b32 v58, 16, v245
  v_and_b32 v59, 0xffff0000, v245
  v_lshlrev_b32 v60, 16, v246
  v_and_b32 v61, 0xffff0000, v246
  v_lshlrev_b32 v62, 16, v247
  v_and_b32 v63, 0xffff0000, v247
  s_waitcnt vmcnt(0)
  v_cvt_pk_bf16_f32 v64, v16, v17
  v_cvt_pk_bf16_f32 v65, v18, v19
  v_cvt_pk_bf16_f32 v66, v20, v21
  v_cvt_pk_bf16_f32 v67, v22, v23
  v_cvt_pk_bf16_f32 v68, v24, v25
  v_cvt_pk_bf16_f32 v69, v26, v27
  v_cvt_pk_bf16_f32 v70, v28, v29
  v_cvt_pk_bf16_f32 v71, v30, v31
  v_lshlrev_b32 v16, 16, v64
  v_and_b32 v17, 0xffff0000, v64
  v_lshlrev_b32 v18, 16, v65
  v_and_b32 v19, 0xffff0000, v65
  v_lshlrev_b32 v20, 16, v66
  v_and_b32 v21, 0xffff0000, v66
  v_lshlrev_b32 v22, 16, v67
  v_and_b32 v23, 0xffff0000, v67
  v_lshlrev_b32 v24, 16, v68
  v_and_b32 v25, 0xffff0000, v68
  v_lshlrev_b32 v26, 16, v69
  v_and_b32 v27, 0xffff0000, v69
  v_lshlrev_b32 v28, 16, v70
  v_and_b32 v29, 0xffff0000, v70
  v_lshlrev_b32 v30, 16, v71
  v_and_b32 v31, 0xffff0000, v71
  v_add_f32 v16, v16, v48
  v_add_f32 v17, v17, v49
  v_add_f32 v18, v18, v50
  v_add_f32 v19, v19, v51
  v_add_f32 v20, v20, v52
  v_add_f32 v21, v21, v53
  v_add_f32 v22, v22, v54
  v_add_f32 v23, v23, v55
  v_add_f32 v24, v24, v56
  v_add_f32 v25, v25, v57
  v_add_f32 v26, v26, v58
  v_add_f32 v27, v27, v59
  v_add_f32 v28, v28, v60
  v_add_f32 v29, v29, v61
  v_add_f32 v30, v30, v62
  v_add_f32 v31, v31, v63
  v_cvt_pk_bf16_f32 v64, v16, v17
  v_cvt_pk_bf16_f32 v65, v18, v19
  v_cvt_pk_bf16_f32 v66, v20, v21
  v_cvt_pk_bf16_f32 v67, v22, v23
  v_cvt_pk_bf16_f32 v68, v24, v25
  v_cvt_pk_bf16_f32 v69, v26, v27
  v_cvt_pk_bf16_f32 v70, v28, v29
  v_cvt_pk_bf16_f32 v71, v30, v31
  v_lshlrev_b32 v16, 16, v64
  v_and_b32 v17, 0xffff0000, v64
  v_lshlrev_b32 v18, 16, v65
  v_and_b32 v19, 0xffff0000, v65
  v_lshlrev_b32 v20, 16, v66
  v_and_b32 v21, 0xffff0000, v66
  v_lshlrev_b32 v22, 16, v67
  v_and_b32 v23, 0xffff0000, v67
  v_lshlrev_b32 v24, 16, v68
  v_and_b32 v25, 0xffff0000, v68
  v_lshlrev_b32 v26, 16, v69
  v_and_b32 v27, 0xffff0000, v69
  v_lshlrev_b32 v28, 16, v70
  v_and_b32 v29, 0xffff0000, v70
  v_lshlrev_b32 v30, 16, v71
  v_and_b32 v31, 0xffff0000, v71
  s_cmp_lg_u32 s52, 0
  s_cbranch_scc1 L_skiph
  ds_write_b128 v15, v[16:19] offset:57856
  ds_write_b128 v15, v[20:23] offset:57872
  ds_write_b128 v15, v[24:27] offset:59904
  ds_write_b128 v15, v[28:31] offset:59920
L_skiph:
  v_add_f32 v48, v16, v17
  v_add_f32 v48, v48, v18
  v_add_f32 v48, v48, v19
  v_add_f32 v48, v48, v20
  v_add_f32 v48, v48, v21
  v_add_f32 v48, v48, v22
  v_add_f32 v48, v48, v23
  s_nop 1
  v_add_f32_dpp v48, v48, v48 quad_perm:[1,0,3,2] row_mask:0xf bank_mask:0xf
  s_nop 1
  v_add_f32_dpp v48, v48, v48 quad_perm:[2,3,0,1] row_mask:0xf bank_mask:0xf
  s_nop 1
  v_add_f32_dpp v48, v48, v48 row_half_mirror row_mask:0xf bank_mask:0xf
  s_nop 1
  v_add_f32_dpp v48, v48, v48 row_mirror row_mask:0xf bank_mask:0xf
  s_nop 1
  v_readlane_b32 s96, v48, 0
  v_readlane_b32 s97, v48, 16
  v_readlane_b32 s98, v48, 32
  v_readlane_b32 s99, v48, 48
  s_nop 2
  v_mov_b32 v48, s96
  v_add_f32 v48, s97, v48
  v_add_f32 v48, s98, v48
  v_add_f32 v48, s99, v48
  v_mul_f32 v48, 0x3b000000, v48
  v_sub_f32 v49, v16, v48
  v_mul_f32 v50, v49, v49
  v_sub_f32 v49, v17, v48
  v_fmac_f32 v50, v49, v49
  v_sub_f32 v49, v18, v48
  v_fmac_f32 v50, v49, v49
  v_sub_f32 v49, v19, v48
  v_fmac_f32 v50, v49, v49
  v_sub_f32 v49, v20, v48
  v_fmac_f32 v50, v49, v49
  v_sub_f32 v49, v21, v48
  v_fmac_f32 v50, v49, v49
  v_sub_f32 v49, v22, v48
  v_fmac_f32 v50, v49, v49
  v_sub_f32 v49, v23, v48
  v_fmac_f32 v50, v49, v49
  s_nop 1
  v_add_f32_dpp v50, v50, v50 quad_perm:[1,0,3,2] row_mask:0xf bank_mask:0xf
  s_nop 1
  v_add_f32_dpp v50, v50, v50 quad_perm:[2,3,0,1] row_mask:0xf bank_mask:0xf
  s_nop 1
  v_add_f32_dpp v50, v50, v50 row_half_mirror row_mask:0xf bank_mask:0xf
  s_nop 1
  v_add_f32_dpp v50, v50, v50 row_mirror row_mask:0xf bank_mask:0xf
  s_nop 1
  v_readlane_b32 s96, v50, 0
  v_readlane_b32 s97, v50, 16
  v_readlane_b32 s98, v50, 32
  v_readlane_b32 s99, v50, 48
  s_nop 2
  v_mov_b32 v50, s96
  v_add_f32 v50, s97, v50
  v_add_f32 v50, s98, v50
  v_add_f32 v50, s99, v50
  v_mul_f32 v50, 0x3b000000, v50
  v_cvt_pk_bf16_f32 v51, v48, v50
  v_lshlrev_b32 v48, 16, v51
  v_and_b32 v50, 0xffff0000, v51
  v_add_f32 v50, 0x3727c5ac, v50
  v_cvt_pk_bf16_f32 v51, v50, v50
  v_lshlrev_b32 v50, 16, v51
  v_and_b32 v49, 0xffff0000, v51
  v_sqrt_f32 v50, v50
  s_nop 0
  v_cvt_pk_bf16_f32 v51, v50, v50
  v_lshlrev_b32 v50, 16, v51
  v_and_b32 v49, 0xffff0000, v51
  v_rcp_f32 v49, v50
  s_nop 0
  v_fma_f32 v51, -v50, v49, 2.0
  v_mul_f32 v49, v49, v51
  v_sub_f32 v52, v16, v48
  v_sub_f32 v53, v17, v48
  v_sub_f32 v54, v18, v48
  v_sub_f32 v55, v19, v48
  v_sub_f32 v56, v20, v48
  v_sub_f32 v57, v21, v48
  v_sub_f32 v58, v22, v48
  v_sub_f32 v59, v23, v48
  v_cvt_pk_bf16_f32 v16, v52, v53
  v_cvt_pk_bf16_f32 v17, v54, v55
  v_cvt_pk_bf16_f32 v18, v56, v57
  v_cvt_pk_bf16_f32 v19, v58, v59
  v_lshlrev_b32 v52, 16, v16
  v_and_b32 v53, 0xffff0000, v16
  v_lshlrev_b32 v54, 16, v17
  v_and_b32 v55, 0xffff0000, v17
  v_lshlrev_b32 v56, 16, v18
  v_and_b32 v57, 0xffff0000, v18
  v_lshlrev_b32 v58, 16, v19
  v_and_b32 v59, 0xffff0000, v19
  v_mul_f32 v52, v52, v49
  v_mul_f32 v53, v53, v49
  v_mul_f32 v54, v54, v49
  v_mul_f32 v55, v55, v49
  v_mul_f32 v56, v56, v49
  v_mul_f32 v57, v57, v49
  v_mul_f32 v58, v58, v49
  v_mul_f32 v59, v59, v49
  v_cvt_pk_bf16_f32 v16, v52, v53
  v_cvt_pk_bf16_f32 v17, v54, v55
  v_cvt_pk_bf16_f32 v18, v56, v57
  v_cvt_pk_bf16_f32 v19, v58, v59
  v_and_b32 v32, 0xffff, v16
  v_lshrrev_b32 v33, 16, v16
  v_and_b32 v34, 0xffff, v17
  v_lshrrev_b32 v35, 16, v17
  v_and_b32 v36, 0xffff, v18
  v_lshrrev_b32 v37, 16, v18
  v_and_b32 v38, 0xffff, v19
  v_lshrrev_b32 v39, 16, v19
  v_add_f32 v48, v24, v25
  v_add_f32 v48, v48, v26
  v_add_f32 v48, v48, v27
  v_add_f32 v48, v48, v28
  v_add_f32 v48, v48, v29
  v_add_f32 v48, v48, v30
  v_add_f32 v48, v48, v31
  s_nop 1
  v_add_f32_dpp v48, v48, v48 quad_perm:[1,0,3,2] row_mask:0xf bank_mask:0xf
  s_nop 1
  v_add_f32_dpp v48, v48, v48 quad_perm:[2,3,0,1] row_mask:0xf bank_mask:0xf
  s_nop 1
  v_add_f32_dpp v48, v48, v48 row_half_mirror row_mask:0xf bank_mask:0xf
  s_nop 1
  v_add_f32_dpp v48, v48, v48 row_mirror row_mask:0xf bank_mask:0xf
  s_nop 1
  v_readlane_b32 s96, v48, 0
  v_readlane_b32 s97, v48, 16
  v_readlane_b32 s98, v48, 32
  v_readlane_b32 s99, v48, 48
  s_nop 2
  v_mov_b32 v48, s96
  v_add_f32 v48, s97, v48
  v_add_f32 v48, s98, v48
  v_add_f32 v48, s99, v48
  v_mul_f32 v48, 0x3b000000, v48
  v_sub_f32 v49, v24, v48
  v_mul_f32 v50, v49, v49
  v_sub_f32 v49, v25, v48
  v_fmac_f32 v50, v49, v49
  v_sub_f32 v49, v26, v48
  v_fmac_f32 v50, v49, v49
  v_sub_f32 v49, v27, v48
  v_fmac_f32 v50, v49, v49
  v_sub_f32 v49, v28, v48
  v_fmac_f32 v50, v49, v49
  v_sub_f32 v49, v29, v48
  v_fmac_f32 v50, v49, v49
  v_sub_f32 v49, v30, v48
  v_fmac_f32 v50, v49, v49
  v_sub_f32 v49, v31, v48
  v_fmac_f32 v50, v49, v49
  s_nop 1
  v_add_f32_dpp v50, v50, v50 quad_perm:[1,0,3,2] row_mask:0xf bank_mask:0xf
  s_nop 1
  v_add_f32_dpp v50, v50, v50 quad_perm:[2,3,0,1] row_mask:0xf bank_mask:0xf
  s_nop 1
  v_add_f32_dpp v50, v50, v50 row_half_mirror row_mask:0xf bank_mask:0xf
  s_nop 1
  v_add_f32_dpp v50, v50, v50 row_mirror row_mask:0xf bank_mask:0xf
  s_nop 1
  v_readlane_b32 s96, v50, 0
  v_readlane_b32 s97, v50, 16
  v_readlane_b32 s98, v50, 32
  v_readlane_b32 s99, v50, 48
  s_nop 2
  v_mov_b32 v50, s96
  v_add_f32 v50, s97, v50
  v_add_f32 v50, s98, v50
  v_add_f32 v50, s99, v50
  v_mul_f32 v50, 0x3b000000, v50
  v_cvt_pk_bf16_f32 v51, v48, v50
  v_lshlrev_b32 v48, 16, v51
  v_and_b32 v50, 0xffff0000, v51
  v_add_f32 v50, 0x3727c5ac, v50
  v_cvt_pk_bf16_f32 v51, v50, v50
  v_lshlrev_b32 v50, 16, v51
  v_and_b32 v49, 0xffff0000, v51
  v_sqrt_f32 v50, v50
  s_nop 0
  v_cvt_pk_bf16_f32 v51, v50, v50
  v_lshlrev_b32 v50, 16, v51
  v_and_b32 v49, 0xffff0000, v51
  v_rcp_f32 v49, v50
  s_nop 0
  v_fma_f32 v51, -v50, v49, 2.0
  v_mul_f32 v49, v49, v51
  v_sub_f32 v52, v24, v48
  v_sub_f32 v53, v25, v48
  v_sub_f32 v54, v26, v48
  v_sub_f32 v55, v27, v48
  v_sub_f32 v56, v28, v48
  v_sub_f32 v57, v29, v48
  v_sub_f32 v58, v30, v48
  v_sub_f32 v59, v31, v48
  v_cvt_pk_bf16_f32 v24, v52, v53
  v_cvt_pk_bf16_f32 v25, v54, v55
  v_cvt_pk_bf16_f32 v26, v56, v57
  v_cvt_pk_bf16_f32 v27, v58, v59
  v_lshlrev_b32 v52, 16, v24
  v_and_b32 v53, 0xffff0000, v24
  v_lshlrev_b32 v54, 16, v25
  v_and_b32 v55, 0xffff0000, v25
  v_lshlrev_b32 v56, 16, v26
  v_and_b32 v57, 0xffff0000, v26
  v_lshlrev_b32 v58, 16, v27
  v_and_b32 v59, 0xffff0000, v27
  v_mul_f32 v52, v52, v49
  v_mul_f32 v53, v53, v49
  v_mul_f32 v54, v54, v49
  v_mul_f32 v55, v55, v49
  v_mul_f32 v56, v56, v49
  v_mul_f32 v57, v57, v49
  v_mul_f32 v58, v58, v49
  v_mul_f32 v59, v59, v49
  v_cvt_pk_bf16_f32 v24, v52, v53
  v_cvt_pk_bf16_f32 v25, v54, v55
  v_cvt_pk_bf16_f32 v26, v56, v57
  v_cvt_pk_bf16_f32 v27, v58, v59
  v_and_b32 v40, 0xffff, v24
  v_lshrrev_b32 v41, 16, v24
  v_and_b32 v42, 0xffff, v25
  v_lshrrev_b32 v43, 16, v25
  v_and_b32 v44, 0xffff, v26
  v_lshrrev_b32 v45, 16, v26
  v_and_b32 v46, 0xffff, v27
  v_lshrrev_b32 v47, 16, v27
  s_lshl_b32 s55, s52, 12
  v_add_u32 v14, s55, v15
  ds_write_b128 v14, v[32:35] offset:2048
  ds_write_b128 v14, v[36:39] offset:2064
  ds_write_b128 v14, v[40:43] offset:4096
  ds_write_b128 v14, v[44:47] offset:4112
  v_lshrrev_b32 v10, 2, v0
  v_lshl_add_u32 v14, v10, 2, s55
  v_mov_b32 v112, 0
  v_mov_b32 v113, 0
  v_mov_b32 v114, 0
  v_mov_b32 v115, 0
  v_mov_b32 v116, 0
  v_mov_b32 v117, 0
  v_mov_b32 v118, 0
  v_mov_b32 v119, 0
  v_mov_b32 v120, 0
  v_mov_b32 v121, 0
  v_mov_b32 v122, 0
  v_mov_b32 v123, 0
  v_mov_b32 v124, 0
  v_mov_b32 v125, 0
  v_mov_b32 v126, 0
  v_mov_b32 v127, 0
  v_mov_b32 v128, 0
  v_mov_b32 v129, 0
  v_mov_b32 v130, 0
  v_mov_b32 v131, 0
  v_mov_b32 v132, 0
  v_mov_b32 v133, 0
  v_mov_b32 v134, 0
  v_mov_b32 v135, 0
  v_mov_b32 v136, 0
  v_mov_b32 v137, 0
  v_mov_b32 v138, 0
  v_mov_b32 v139, 0
  v_mov_b32 v140, 0
  v_mov_b32 v141, 0
  v_mov_b32 v142, 0
  v_mov_b32 v143, 0
  s_waitcnt lgkmcnt(0)
  ds_read_b32 v16, v14 offset:2048
  ds_read_b32 v17, v14 offset:2560
  ds_read_b32 v18, v14 offset:3072
  ds_read_b32 v19, v14 offset:3584
  ds_read_b32 v20, v14 offset:4096
  ds_read_b32 v21, v14 offset:4608
  ds_read_b32 v22, v14 offset:5120
  ds_read_b32 v23, v14 offset:5632
  s_waitcnt lgkmcnt(0)
  v_lshlrev_b32 v24, 16, v16
  v_lshlrev_b32 v25, 16, v17
  v_lshlrev_b32 v26, 16, v18
  v_lshlrev_b32 v27, 16, v19
  v_lshlrev_b32 v28, 16, v20
  v_lshlrev_b32 v29, 16, v21
  v_lshlrev_b32 v30, 16, v22
  v_lshlrev_b32 v31, 16, v23
  s_nop 1
  v_dot2_f32_bf16 v112, v192, v16, v112
  v_dot2_f32_bf16 v114, v193, v16, v114
  v_dot2_f32_bf16 v116, v194, v16, v116
  v_dot2_f32_bf16 v118, v195, v16, v118
  v_dot2_f32_bf16 v113, v192, v24, v113
  v_dot2_f32_bf16 v115, v193, v24, v115
  v_dot2_f32_bf16 v117, v194, v24, v117
  v_dot2_f32_bf16 v119, v195, v24, v119
  v_dot2_f32_bf16 v120, v192, v20, v120
  v_dot2_f32_bf16 v122, v193, v20, v122
  v_dot2_f32_bf16 v124, v194, v20, v124
  v_dot2_f32_bf16 v126, v195, v20, v126
  v_dot2_f32_bf16 v121, v192, v28, v121
  v_dot2_f32_bf16 v123, v193, v28, v123
  v_dot2_f32_bf16 v125, v194, v28, v125
  v_dot2_f32_bf16 v127, v195, v28, v127
  v_dot2_f32_bf16 v128, v208, v16, v128
  v_dot2_f32_bf16 v130, v209, v16, v130
  v_dot2_f32_bf16 v132, v210, v16, v132
  v_dot2_f32_bf16 v134, v211, v16, v134
  v_dot2_f32_bf16 v129, v208, v24, v129
  v_dot2_f32_bf16 v131, v209, v24, v131
  v_dot2_f32_bf16 v133, v210, v24, v133
  v_dot2_f32_bf16 v135, v211, v24, v135
  v_dot2_f32_bf16 v136, v208, v20, v136
  v_dot2_f32_bf16 v138, v209, v20, v138
  v_dot2_f32_bf16 v140, v210, v20, v140
  v_dot2_f32_bf16 v142, v211, v20, v142
  v_dot2_f32_bf16 v137, v208, v28, v137
  v_dot2_f32_bf16 v139, v209, v28, v139
  v_dot2_f32_bf16 v141, v210, v28, v141
  v_dot2_f32_bf16 v143, v211, v28, v143
  v_dot2_f32_bf16 v112, v196, v17, v112
  v_dot2_f32_bf16 v114, v197, v17, v114
  v_dot2_f32_bf16 v116, v198, v17, v116
  v_dot2_f32_bf16 v118, v199, v17, v118
  v_dot2_f32_bf16 v113, v196, v25, v113
  v_dot2_f32_bf16 v115, v197, v25, v115
  v_dot2_f32_bf16 v117, v198, v25, v117
  v_dot2_f32_bf16 v119, v199, v25, v119
  v_dot2_f32_bf16 v120, v196, v21, v120
  v_dot2_f32_bf16 v122, v197, v21, v122
  v_dot2_f32_bf16 v124, v198, v21, v124
  v_dot2_f32_bf16 v126, v199, v21, v126
  v_dot2_f32_bf16 v121, v196, v29, v121
  v_dot2_f32_bf16 v123, v197, v29, v123
  v_dot2_f32_bf16 v125, v198, v29, v125
  v_dot2_f32_bf16 v127, v199, v29, v127
  v_dot2_f32_bf16 v128, v212, v17, v128
  v_dot2_f32_bf16 v130, v213, v17, v130
  v_dot2_f32_bf16 v132, v214, v17, v132
  v_dot2_f32_bf16 v134, v215, v17, v134
  v_dot2_f32_bf16 v129, v212, v25, v129
  v_dot2_f32_bf16 v131, v213, v25, v131
  v_dot2_f32_bf16 v133, v214, v25, v133
  v_dot2_f32_bf16 v135, v215, v25, v135
  v_dot2_f32_bf16 v136, v212, v21, v136
  v_dot2_f32_bf16 v138, v213, v21, v138
  v_dot2_f32_bf16 v140, v214, v21, v140
  v_dot2_f32_bf16 v142, v215, v21, v142
  v_dot2_f32_bf16 v137, v212, v29, v137
  v_dot2_f32_bf16 v139, v213, v29, v139
  v_dot2_f32_bf16 v141, v214, v29, v141
  v_dot2_f32_bf16 v143, v215, v29, v143
  v_dot2_f32_bf16 v112, v200, v18, v112
  v_dot2_f32_bf16 v114, v201, v18, v114
  v_dot2_f32_bf16 v116, v202, v18, v116
  v_dot2_f32_bf16 v118, v203, v18, v118
  v_dot2_f32_bf16 v113, v200, v26, v113
  v_dot2_f32_bf16 v115, v201, v26, v115
  v_dot2_f32_bf16 v117, v202, v26, v117
  v_dot2_f32_bf16 v119, v203, v26, v119
  v_dot2_f32_bf16 v120, v200, v22, v120
  v_dot2_f32_bf16 v122, v201, v22, v122
  v_dot2_f32_bf16 v124, v202, v22, v124
  v_dot2_f32_bf16 v126, v203, v22, v126
  v_dot2_f32_bf16 v121, v200, v30, v121
  v_dot2_f32_bf16 v123, v201, v30, v123
  v_dot2_f32_bf16 v125, v202, v30, v125
  v_dot2_f32_bf16 v127, v203, v30, v127
  v_dot2_f32_bf16 v128, v216, v18, v128
  v_dot2_f32_bf16 v130, v217, v18, v130
  v_dot2_f32_bf16 v132, v218, v18, v132
  v_dot2_f32_bf16 v134, v219, v18, v134
  v_dot2_f32_bf16 v129, v216, v26, v129
  v_dot2_f32_bf16 v131, v217, v26, v131
  v_dot2_f32_bf16 v133, v218, v26, v133
  v_dot2_f32_bf16 v135, v219, v26, v135
  v_dot2_f32_bf16 v136, v216, v22, v136
  v_dot2_f32_bf16 v138, v217, v22, v138
  v_dot2_f32_bf16 v140, v218, v22, v140
  v_dot2_f32_bf16 v142, v219, v22, v142
  v_dot2_f32_bf16 v137, v216, v30, v137
  v_dot2_f32_bf16 v139, v217, v30, v139
  v_dot2_f32_bf16 v141, v218, v30, v141
  v_dot2_f32_bf16 v143, v219, v30, v143
  v_dot2_f32_bf16 v112, v204, v19, v112
  v_dot2_f32_bf16 v114, v205, v19, v114
  v_dot2_f32_bf16 v116, v206, v19, v116
  v_dot2_f32_bf16 v118, v207, v19, v118
  v_dot2_f32_bf16 v113, v204, v27, v113
  v_dot2_f32_bf16 v115, v205, v27, v115
  v_dot2_f32_bf16 v117, v206, v27, v117
  v_dot2_f32_bf16 v119, v207, v27, v119
  v_dot2_f32_bf16 v120, v204, v23, v120
  v_dot2_f32_bf16 v122, v205, v23, v122
  v_dot2_f32_bf16 v124, v206, v23, v124
  v_dot2_f32_bf16 v126, v207, v23, v126
  v_dot2_f32_bf16 v121, v204, v31, v121
  v_dot2_f32_bf16 v123, v205, v31, v123
  v_dot2_f32_bf16 v125, v206, v31, v125
  v_dot2_f32_bf16 v127, v207, v31, v127
  v_dot2_f32_bf16 v128, v220, v19, v128
  v_dot2_f32_bf16 v130, v221, v19, v130
  v_dot2_f32_bf16 v132, v222, v19, v132
  v_dot2_f32_bf16 v134, v223, v19, v134
  v_dot2_f32_bf16 v129, v220, v27, v129
  v_dot2_f32_bf16 v131, v221, v27, v131
  v_dot2_f32_bf16 v133, v222, v27, v133
  v_dot2_f32_bf16 v135, v223, v27, v135
  v_dot2_f32_bf16 v136, v220, v23, v136
  v_dot2_f32_bf16 v138, v221, v23, v138
  v_dot2_f32_bf16 v140, v222, v23, v140
  v_dot2_f32_bf16 v142, v223, v23, v142
  v_dot2_f32_bf16 v137, v220, v31, v137
  v_dot2_f32_bf16 v139, v221, v31, v139
  v_dot2_f32_bf16 v141, v222, v31, v141
  v_dot2_f32_bf16 v143, v223, v31, v143
  s_nop 2
  v_add_f32_dpp v112, v112, v112 row_ror:4 row_mask:0xf bank_mask:0xf
  v_add_f32_dpp v113, v113, v113 row_ror:4 row_mask:0xf bank_mask:0xf
  v_add_f32_dpp v114, v114, v114 row_ror:4 row_mask:0xf bank_mask:0xf
  v_add_f32_dpp v115, v115, v115 row_ror:4 row_mask:0xf bank_mask:0xf
  v_add_f32_dpp v116, v116, v116 row_ror:4 row_mask:0xf bank_mask:0xf
  v_add_f32_dpp v117, v117, v117 row_ror:4 row_mask:0xf bank_mask:0xf
  v_add_f32_dpp v118, v118, v118 row_ror:4 row_mask:0xf bank_mask:0xf
  v_add_f32_dpp v119, v119, v119 row_ror:4 row_mask:0xf bank_mask:0xf
  v_add_f32_dpp v120, v120, v120 row_ror:4 row_mask:0xf bank_mask:0xf
  v_add_f32_dpp v121, v121, v121 row_ror:4 row_mask:0xf bank_mask:0xf
  v_add_f32_dpp v122, v122, v122 row_ror:4 row_mask:0xf bank_mask:0xf
  v_add_f32_dpp v123, v123, v123 row_ror:4 row_mask:0xf bank_mask:0xf
  v_add_f32_dpp v124, v124, v124 row_ror:4 row_mask:0xf bank_mask:0xf
  v_add_f32_dpp v125, v125, v125 row_ror:4 row_mask:0xf bank_mask:0xf
  v_add_f32_dpp v126, v126, v126 row_ror:4 row_mask:0xf bank_mask:0xf
  v_add_f32_dpp v127, v127, v127 row_ror:4 row_mask:0xf bank_mask:0xf
  v_add_f32_dpp v128, v128, v128 row_ror:4 row_mask:0xf bank_mask:0xf
  v_add_f32_dpp v129, v129, v129 row_ror:4 row_mask:0xf bank_mask:0xf
  v_add_f32_dpp v130, v130, v130 row_ror:4 row_mask:0xf bank_mask:0xf
  v_add_f32_dpp v131, v131, v131 row_ror:4 row_mask:0xf bank_mask:0xf
  v_add_f32_dpp v132, v132, v132 row_ror:4 row_mask:0xf bank_mask:0xf
  v_add_f32_dpp v133, v133, v133 row_ror:4 row_mask:0xf bank_mask:0xf
  v_add_f32_dpp v134, v134, v134 row_ror:4 row_mask:0xf bank_mask:0xf
  v_add_f32_dpp v135, v135, v135 row_ror:4 row_mask:0xf bank_mask:0xf
  v_add_f32_dpp v136, v136, v136 row_ror:4 row_mask:0xf bank_mask:0xf
  v_add_f32_dpp v137, v137, v137 row_ror:4 row_mask:0xf bank_mask:0xf
  v_add_f32_dpp v138, v138, v138 row_ror:4 row_mask:0xf bank_mask:0xf
  v_add_f32_dpp v139, v139, v139 row_ror:4 row_mask:0xf bank_mask:0xf
  v_add_f32_dpp v140, v140, v140 row_ror:4 row_mask:0xf bank_mask:0xf
  v_add_f32_dpp v141, v141, v141 row_ror:4 row_mask:0xf bank_mask:0xf
  v_add_f32_dpp v142, v142, v142 row_ror:4 row_mask:0xf bank_mask:0xf
  v_add_f32_dpp v143, v143, v143 row_ror:4 row_mask:0xf bank_mask:0xf
  v_add_f32_dpp v112, v112, v112 row_ror:8 row_mask:0xf bank_mask:0xf
  v_add_f32_dpp v113, v113, v113 row_ror:8 row_mask:0xf bank_mask:0xf
  v_add_f32_dpp v114, v114, v114 row_ror:8 row_mask:0xf bank_mask:0xf
  v_add_f32_dpp v115, v115, v115 row_ror:8 row_mask:0xf bank_mask:0xf
  v_add_f32_dpp v116, v116, v116 row_ror:8 row_mask:0xf bank_mask:0xf
  v_add_f32_dpp v117, v117, v117 row_ror:8 row_mask:0xf bank_mask:0xf
  v_add_f32_dpp v118, v118, v118 row_ror:8 row_mask:0xf bank_mask:0xf
  v_add_f32_dpp v119, v119, v119 row_ror:8 row_mask:0xf bank_mask:0xf
  v_add_f32_dpp v120, v120, v120 row_ror:8 row_mask:0xf bank_mask:0xf
  v_add_f32_dpp v121, v121, v121 row_ror:8 row_mask:0xf bank_mask:0xf
  v_add_f32_dpp v122, v122, v122 row_ror:8 row_mask:0xf bank_mask:0xf
  v_add_f32_dpp v123, v123, v123 row_ror:8 row_mask:0xf bank_mask:0xf
  v_add_f32_dpp v124, v124, v124 row_ror:8 row_mask:0xf bank_mask:0xf
  v_add_f32_dpp v125, v125, v125 row_ror:8 row_mask:0xf bank_mask:0xf
  v_add_f32_dpp v126, v126, v126 row_ror:8 row_mask:0xf bank_mask:0xf
  v_add_f32_dpp v127, v127, v127 row_ror:8 row_mask:0xf bank_mask:0xf
  v_add_f32_dpp v128, v128, v128 row_ror:8 row_mask:0xf bank_mask:0xf
  v_add_f32_dpp v129, v129, v129 row_ror:8 row_mask:0xf bank_mask:0xf
  v_add_f32_dpp v130, v130, v130 row_ror:8 row_mask:0xf bank_mask:0xf
  v_add_f32_dpp v131, v131, v131 row_ror:8 row_mask:0xf bank_mask:0xf
  v_add_f32_dpp v132, v132, v132 row_ror:8 row_mask:0xf bank_mask:0xf
  v_add_f32_dpp v133, v133, v133 row_ror:8 row_mask:0xf bank_mask:0xf
  v_add_f32_dpp v134, v134, v134 row_ror:8 row_mask:0xf bank_mask:0xf
  v_add_f32_dpp v135, v135, v135 row_ror:8 row_mask:0xf bank_mask:0xf
  v_add_f32_dpp v136, v136, v136 row_ror:8 row_mask:0xf bank_mask:0xf
  v_add_f32_dpp v137, v137, v137 row_ror:8 row_mask:0xf bank_mask:0xf
  v_add_f32_dpp v138, v138, v138 row_ror:8 row_mask:0xf bank_mask:0xf
  v_add_f32_dpp v139, v139, v139 row_ror:8 row_mask:0xf bank_mask:0xf
  v_add_f32_dpp v140, v140, v140 row_ror:8 row_mask:0xf bank_mask:0xf
  v_add_f32_dpp v141, v141, v141 row_ror:8 row_mask:0xf bank_mask:0xf
  v_add_f32_dpp v142, v142, v142 row_ror:8 row_mask:0xf bank_mask:0xf
  v_add_f32_dpp v143, v143, v143 row_ror:8 row_mask:0xf bank_mask:0xf
  v_and_b32 v9, 3, v0
  v_lshrrev_b32 v14, 4, v0
  v_lshlrev_b32 v14, 9, v14
  v_lshl_add_u32 v14, v9, 5, v14
  v_and_b32 v15, 15, v0
  v_cmp_gt_u32 vcc, 4, v15
  s_and_saveexec_b64 s[60:61], vcc
  ds_write_b128 v14, v[112:115] offset:34816
  ds_write_b128 v14, v[116:119] offset:34832
  ds_write_b128 v14, v[120:123] offset:34944
  ds_write_b128 v14, v[124:127] offset:34960
  ds_write_b128 v14, v[128:131] offset:35072
  ds_write_b128 v14, v[132:135] offset:35088
  ds_write_b128 v14, v[136:139] offset:35200
  ds_write_b128 v14, v[140:143] offset:35216
  s_mov_b64 exec, s[60:61]
  s_waitcnt lgkmcnt(0)
  s_barrier
  s_cmp_lg_u32 s52, 0
  s_cbranch_scc1 L_skipact
  v_lshlrev_b32 v15, 2, v0
  ds_read_b32 v16, v15 offset:34816
  ds_read_b32 v48, v15 offset:35072
  ds_read_b32 v17, v15 offset:35328
  ds_read_b32 v49, v15 offset:35584
  ds_read_b32 v18, v15 offset:35840
  ds_read_b32 v50, v15 offset:36096
  ds_read_b32 v19, v15 offset:36352
  ds_read_b32 v51, v15 offset:36608
  ds_read_b32 v20, v15 offset:36864
  ds_read_b32 v52, v15 offset:37120
  ds_read_b32 v21, v15 offset:37376
  ds_read_b32 v53, v15 offset:37632
  ds_read_b32 v22, v15 offset:37888
  ds_read_b32 v54, v15 offset:38144
  ds_read_b32 v23, v15 offset:38400
  ds_read_b32 v55, v15 offset:38656
  ds_read_b32 v24, v15 offset:38912
  ds_read_b32 v56, v15 offset:39168
  ds_read_b32 v25, v15 offset:39424
  ds_read_b32 v57, v15 offset:39680
  ds_read_b32 v26, v15 offset:39936
  ds_read_b32 v58, v15 offset:40192
  ds_read_b32 v27, v15 offset:40448
  ds_read_b32 v59, v15 offset:40704
  ds_read_b32 v28, v15 offset:40960
  ds_read_b32 v60, v15 offset:41216
  ds_read_b32 v29, v15 offset:41472
  ds_read_b32 v61, v15 offset:41728
  ds_read_b32 v30, v15 offset:41984
  ds_read_b32 v62, v15 offset:42240
  ds_read_b32 v31, v15 offset:42496
  ds_read_b32 v63, v15 offset:42752
  ds_read_b32 v32, v15 offset:43008
  ds_read_b32 v64, v15 offset:43264
  ds_read_b32 v33, v15 offset:43520
  ds_read_b32 v65, v15 offset:43776
  ds_read_b32 v34, v15 offset:44032
  ds_read_b32 v66, v15 offset:44288
  ds_read_b32 v35, v15 offset:44544
  ds_read_b32 v67, v15 offset:44800
  ds_read_b32 v36, v15 offset:45056
  ds_read_b32 v68, v15 offset:45312
  ds_read_b32 v37, v15 offset:45568
  ds_read_b32 v69, v15 offset:45824
  ds_read_b32 v38, v15 offset:46080
  ds_read_b32 v70, v15 offset:46336
  ds_read_b32 v39, v15 offset:46592
  ds_read_b32 v71, v15 offset:46848
  ds_read_b32 v40, v15 offset:47104
  ds_read_b32 v72, v15 offset:47360
  ds_read_b32 v41, v15 offset:47616
  ds_read_b32 v73, v15 offset:47872
  ds_read_b32 v42, v15 offset:48128
  ds_read_b32 v74, v15 offset:48384
  ds_read_b32 v43, v15 offset:48640
  ds_read_b32 v75, v15 offset:48896
  ds_read_b32 v44, v15 offset:49152
  ds_read_b32 v76, v15 offset:49408
  ds_read_b32 v45, v15 offset:49664
  ds_read_b32 v77, v15 offset:49920
  ds_read_b32 v46, v15 offset:50176
  ds_read_b32 v78, v15 offset:50432
  ds_read_b32 v47, v15 offset:50688
  ds_read_b32 v79, v15 offset:50944
  s_waitcnt lgkmcnt(0)
  v_add_f32 v16, v16, v32
  v_add_f32 v48, v48, v64
  v_add_f32 v17, v17, v33
  v_add_f32 v49, v49, v65
  v_add_f32 v18, v18, v34
  v_add_f32 v50, v50, v66
  v_add_f32 v19, v19, v35
  v_add_f32 v51, v51, v67
  v_add_f32 v20, v20, v36
  v_add_f32 v52, v52, v68
  v_add_f32 v21, v21, v37
  v_add_f32 v53, v53, v69
  v_add_f32 v22, v22, v38
  v_add_f32 v54, v54, v70
  v_add_f32 v23, v23, v39
  v_add_f32 v55, v55, v71
  v_add_f32 v24, v24, v40
  v_add_f32 v56, v56, v72
  v_add_f32 v25, v25, v41
  v_add_f32 v57, v57, v73
  v_add_f32 v26, v26, v42
  v_add_f32 v58, v58, v74
  v_add_f32 v27, v27, v43
  v_add_f32 v59, v59, v75
  v_add_f32 v28, v28, v44
  v_add_f32 v60, v60, v76
  v_add_f32 v29, v29, v45
  v_add_f32 v61, v61, v77
  v_add_f32 v30, v30, v46
  v_add_f32 v62, v62, v78
  v_add_f32 v31, v31, v47
  v_add_f32 v63, v63, v79
  v_add_f32 v16, v16, v24
  v_add_f32 v48, v48, v56
  v_add_f32 v17, v17, v25
  v_add_f32 v49, v49, v57
  v_add_f32 v18, v18, v26
  v_add_f32 v50, v50, v58
  v_add_f32 v19, v19, v27
  v_add_f32 v51, v51, v59
  v_add_f32 v20, v20, v28
  v_add_f32 v52, v52, v60
  v_add_f32 v21, v21, v29
  v_add_f32 v53, v53, v61
  v_add_f32 v22, v22, v30
  v_add_f32 v54, v54, v62
  v_add_f32 v23, v23, v31
  v_add_f32 v55, v55, v63
  v_add_f32 v16, v16, v20
  v_add_f32 v48, v48, v52
  v_add_f32 v17, v17, v21
  v_add_f32 v49, v49, v53
  v_add_f32 v18, v18, v22
  v_add_f32 v50, v50, v54
  v_add_f32 v19, v19, v23
  v_add_f32 v51, v51, v55
  v_add_f32 v16, v16, v18
  v_add_f32 v48, v48, v50
  v_add_f32 v17, v17, v19
  v_add_f32 v49, v49, v51
  v_add_f32 v16, v16, v17
  v_add_f32 v48, v48, v49
  v_cvt_pk_bf16_f32 v178, v16, v48
  v_lshlrev_b32 v16, 16, v178
  v_and_b32 v48, 0xffff0000, v178
  v_mul_f32 v178, s57, v16
  v_exp_f32 v178, -v178
  s_nop 0
  v_add_f32 v178, 1.0, v178
  v_rcp_f32 v179, v178
  s_nop 0
  v_fma_f32 v180, -v178, v179, 2.0
  v_mul_f32 v179, v179, v180
  v_mul_f32 v16, v16, v179
  v_cvt_pk_bf16_f32 v178, v16, v16
  v_lshlrev_b32 v16, 16, v178
  v_and_b32 v17, 0xffff0000, v178
  v_mul_f32 v16, v16, v48
  v_cvt_pk_bf16_f32 v16, v16, 0
  ds_write_b32 v15, v16 offset:57600
  s_waitcnt lgkmcnt(0)
L_skipact:
  s_barrier
  s_lshl_b32 s55, s52, 2
  v_mov_b32 v15, s55
  ds_read_b32 v16, v15 offset:57600
  ds_read_b32 v17, v15 offset:57632
  ds_read_b32 v18, v15 offset:57664
  ds_read_b32 v19, v15 offset:57696
  ds_read_b32 v20, v15 offset:57728
  ds_read_b32 v21, v15 offset:57760
  ds_read_b32 v22, v15 offset:57792
  ds_read_b32 v23, v15 offset:57824
  v_mov_b32 v112, 0
  v_mov_b32 v113, 0
  v_mov_b32 v114, 0
  v_mov_b32 v115, 0
  v_mov_b32 v116, 0
  v_mov_b32 v117, 0
  v_mov_b32 v118, 0
  v_mov_b32 v119, 0
  v_mov_b32 v120, 0
  v_mov_b32 v121, 0
  v_mov_b32 v122, 0
  v_mov_b32 v123, 0
  v_mov_b32 v124, 0
  v_mov_b32 v125, 0
  v_mov_b32 v126, 0
  v_mov_b32 v127, 0
  s_waitcnt lgkmcnt(0)
  v_lshlrev_b32 v24, 16, v16
  v_lshlrev_b32 v25, 16, v17
  v_lshlrev_b32 v26, 16, v18
  v_lshlrev_b32 v27, 16, v19
  v_lshlrev_b32 v28, 16, v20
  v_lshlrev_b32 v29, 16, v21
  v_lshlrev_b32 v30, 16, v22
  v_lshlrev_b32 v31, 16, v23
  s_nop 1
  v_dot2_f32_bf16 v112, v224, v16, v112
  v_dot2_f32_bf16 v114, v225, v16, v114
  v_dot2_f32_bf16 v116, v226, v16, v116
  v_dot2_f32_bf16 v118, v227, v16, v118
  v_dot2_f32_bf16 v113, v224, v24, v113
  v_dot2_f32_bf16 v115, v225, v24, v115
  v_dot2_f32_bf16 v117, v226, v24, v117
  v_dot2_f32_bf16 v119, v227, v24, v119
  v_dot2_f32_bf16 v120, v224, v20, v120
  v_dot2_f32_bf16 v122, v225, v20, v122
  v_dot2_f32_bf16 v124, v226, v20, v124
  v_dot2_f32_bf16 v126, v227, v20, v126
  v_dot2_f32_bf16 v121, v224, v28, v121
  v_dot2_f32_bf16 v123, v225, v28, v123
  v_dot2_f32_bf16 v125, v226, v28, v125
  v_dot2_f32_bf16 v127, v227, v28, v127
  v_dot2_f32_bf16 v112, v228, v17, v112
  v_dot2_f32_bf16 v114, v229, v17, v114
  v_dot2_f32_bf16 v116, v230, v17, v116
  v_dot2_f32_bf16 v118, v231, v17, v118
  v_dot2_f32_bf16 v113, v228, v25, v113
  v_dot2_f32_bf16 v115, v229, v25, v115
  v_dot2_f32_bf16 v117, v230, v25, v117
  v_dot2_f32_bf16 v119, v231, v25, v119
  v_dot2_f32_bf16 v120, v228, v21, v120
  v_dot2_f32_bf16 v122, v229, v21, v122
  v_dot2_f32_bf16 v124, v230, v21, v124
  v_dot2_f32_bf16 v126, v231, v21, v126
  v_dot2_f32_bf16 v121, v228, v29, v121
  v_dot2_f32_bf16 v123, v229, v29, v123
  v_dot2_f32_bf16 v125, v230, v29, v125
  v_dot2_f32_bf16 v127, v231, v29, v127
  v_dot2_f32_bf16 v112, v232, v18, v112
  v_dot2_f32_bf16 v114, v233, v18, v114
  v_dot2_f32_bf16 v116, v234, v18, v116
  v_dot2_f32_bf16 v118, v235, v18, v118
  v_dot2_f32_bf16 v113, v232, v26, v113
  v_dot2_f32_bf16 v115, v233, v26, v115
  v_dot2_f32_bf16 v117, v234, v26, v117
  v_dot2_f32_bf16 v119, v235, v26, v119
  v_dot2_f32_bf16 v120, v232, v22, v120
  v_dot2_f32_bf16 v122, v233, v22, v122
  v_dot2_f32_bf16 v124, v234, v22, v124
  v_dot2_f32_bf16 v126, v235, v22, v126
  v_dot2_f32_bf16 v121, v232, v30, v121
  v_dot2_f32_bf16 v123, v233, v30, v123
  v_dot2_f32_bf16 v125, v234, v30, v125
  v_dot2_f32_bf16 v127, v235, v30, v127
  v_dot2_f32_bf16 v112, v236, v19, v112
  v_dot2_f32_bf16 v114, v237, v19, v114
  v_dot2_f32_bf16 v116, v238, v19, v116
  v_dot2_f32_bf16 v118, v239, v19, v118
  v_dot2_f32_bf16 v113, v236, v27, v113
  v_dot2_f32_bf16 v115, v237, v27, v115
  v_dot2_f32_bf16 v117, v238, v27, v117
  v_dot2_f32_bf16 v119, v239, v27, v119
  v_dot2_f32_bf16 v120, v236, v23, v120
  v_dot2_f32_bf16 v122, v237, v23, v122
  v_dot2_f32_bf16 v124, v238, v23, v124
  v_dot2_f32_bf16 v126, v239, v23, v126
  v_dot2_f32_bf16 v121, v236, v31, v121
  v_dot2_f32_bf16 v123, v237, v31, v123
  v_dot2_f32_bf16 v125, v238, v31, v125
  v_dot2_f32_bf16 v127, v239, v31, v127
  s_nop 2
  s_lshl_b32 s55, s52, 12
  v_lshlrev_b32 v14, 5, v1
  v_add_u32 v14, s55, v14
  ds_write_b128 v14, v[112:115] offset:2048
  ds_write_b128 v14, v[116:119] offset:2064
  ds_write_b128 v14, v[120:123] offset:4096
  ds_write_b128 v14, v[124:127] offset:4112
  s_waitcnt lgkmcnt(0)
  s_barrier
  v_lshlrev_b32 v15, 2, v0
  ds_read_b32 v16, v15 offset:2048
  ds_read_b32 v24, v15 offset:4096
  ds_read_b32 v17, v15 offset:6144
  ds_read_b32 v25, v15 offset:8192
  ds_read_b32 v18, v15 offset:10240
  ds_read_b32 v26, v15 offset:12288
  ds_read_b32 v19, v15 offset:14336
  ds_read_b32 v27, v15 offset:16384
  ds_read_b32 v20, v15 offset:18432
  ds_read_b32 v28, v15 offset:20480
  ds_read_b32 v21, v15 offset:22528
  ds_read_b32 v29, v15 offset:24576
  ds_read_b32 v22, v15 offset:26624
  ds_read_b32 v30, v15 offset:28672
  ds_read_b32 v23, v15 offset:30720
  ds_read_b32 v31, v15 offset:32768
  ds_read_b32 v32, v15 offset:57856
  ds_read_b32 v33, v15 offset:59904
  s_waitcnt lgkmcnt(0)
  v_add_f32 v16, v16, v20
  v_add_f32 v24, v24, v28
  v_add_f32 v17, v17, v21
  v_add_f32 v25, v25, v29
  v_add_f32 v18, v18, v22
  v_add_f32 v26, v26, v30
  v_add_f32 v19, v19, v23
  v_add_f32 v27, v27, v31
  v_add_f32 v16, v16, v18
  v_add_f32 v24, v24, v26
  v_add_f32 v17, v17, v19
  v_add_f32 v25, v25, v27
  v_add_f32 v16, v16, v17
  v_add_f32 v24, v24, v25
  s_mov_b32 s55, 528384
  buffer_atomic_add_f32 v16, v15, s[40:43], s55 offen sc1
  buffer_atomic_add_f32 v24, v15, s[40:43], s55 offen offset:2048 sc1
  s_waitcnt vmcnt(0)
  s_barrier
  s_cmp_lg_u32 s52, 0
  s_cbranch_scc1 L_skipcc
  v_mov_b32 v14, 1
  v_mov_b32 v13, 0
  v_cmp_eq_u32 vcc, 0, v0
  s_and_saveexec_b64 s[60:61], vcc
  buffer_atomic_add v14, v13, s[44:47], 0 offen offset:160 sc0 sc1
  s_waitcnt vmcnt(0)
  ds_write_b32 v13, v14 offset:56320
  s_mov_b64 exec, s[60:61]
  s_waitcnt lgkmcnt(0)
L_skipcc:
  s_barrier
  v_mov_b32 v13, 0
  ds_read_b32 v14, v13 offset:56320
  s_waitcnt lgkmcnt(0)
  v_readfirstlane_b32 s55, v14
  s_cmp_lg_u32 s55, 55
  s_cbranch_scc1 L_end
  s_mov_b32 s55, 528384
  buffer_load_dword v16, v15, s[40:43], s55 offen sc1
  buffer_load_dword v17, v15, s[40:43], s55 offen offset:2048 sc1
  v_lshlrev_b32 v14, 1, v0
  s_waitcnt vmcnt(0)
  v_cvt_pk_bf16_f32 v18, v16, v17
  v_lshlrev_b32 v16, 16, v18
  v_and_b32 v17, 0xffff0000, v18
  v_add_f32 v16, v16, v32
  v_add_f32 v17, v17, v33
  v_cvt_pk_bf16_f32 v16, v16, v17
  v_lshrrev_b32 v17, 16, v16
  buffer_store_short v16, v14, s[84:87], 0 offen
  buffer_store_short v17, v14, s[84:87], 0 offen offset:1024
L_end:
  s_endpgm
.section .rodata,"a"
.p2align 6
.amdhsa_kernel sequential_preLN__mha_block_cached__swiglu_ffn__decode_kernel
  .amdhsa_next_free_vgpr 256
  .amdhsa_next_free_sgpr 102
  .amdhsa_accum_offset 256
  .amdhsa_group_segment_fixed_size 0
  .amdhsa_kernarg_size 96
  .amdhsa_user_sgpr_count 2
  .amdhsa_user_sgpr_kernarg_segment_ptr 1
  .amdhsa_system_sgpr_workgroup_id_x 1
  .amdhsa_float_denorm_mode_32 3
.end_amdhsa_kernel
```
